```python
import torch

def _softmax(x, axis=-1):
    return torch.softmax(x, dim=axis)
def _gelu(x):
    return torch.nn.functional.gelu(x, approximate="tanh")
def _silu(x):
    return torch.nn.functional.silu(x)
def _sigmoid(x):
    return torch.sigmoid(x)
def _layernorm(x, axis=-1, eps=1e-5):
    m = x.mean(dim=axis, keepdim=True)
    v = x.var(dim=axis, keepdim=True, unbiased=False)
    return (x - m) / torch.sqrt(v + eps)
def _scatter_add(tgt, idx, src, axis=0):
    return tgt.clone().index_add_(axis, idx, src)
def _segment_sum(src, seg, n):
    out = torch.zeros((n,) + src.shape[1:], dtype=src.dtype)
    return out.index_add_(0, seg, src)
def _pad(x, pw):
    flat = tuple(v for pair in reversed(pw) for v in pair)
    return torch.nn.functional.pad(x, flat)

kernel_name = 'standalone__mha_softmax__sampling'

def setup_inputs():

    _w = (lambda a: (lambda t: t.to(torch.bfloat16) if t.is_floating_point() else t)(torch.as_tensor(a)))
    B, H, Sq, Sk, D = 8, 32, 8, 4096, 128
    return {
        "q": _w((lambda *s: torch.randn(*s, dtype=torch.bfloat16) * 0.8)(B, H, Sq, D)),
        "k": _w((lambda *s: torch.randn(*s, dtype=torch.bfloat16) * 0.8)(B, H, Sk, D)),
        "v": _w((lambda *s: torch.randn(*s, dtype=torch.bfloat16) * 0.05)(B, H, Sk, D)),
    }

def reference(q, k, v):
    scale = q.shape[-1] ** -0.5
    scores = torch.einsum("bhqd,bhkd->bhqk", q, k) * scale
    p = _softmax(scores, axis=-1)
    return torch.einsum("bhqk,bhkd->bhqd", p, v)
```

```asm
; @launch grid=(256,1,1) block=(128,1,1) lds=131264
.amdgcn_target "amdgcn-amd-amdhsa--gfx950"
.text
.globl standalone__mha_softmax__sampling_kernel
.p2align 8
.type standalone__mha_softmax__sampling_kernel,@function
standalone__mha_softmax__sampling_kernel:
    s_cmp_ge_u32 s2, 256
    s_cbranch_scc1 L_end
    s_load_dwordx4 s[4:7], s[0:1], 0
    s_load_dwordx4 s[8:11], s[0:1], 16
    s_load_dwordx2 s[56:57], s[0:1], 40
    v_readfirstlane_b32 s28, v0
    v_and_b32 v1, 63, v0
    s_getpc_b64 s[48:49]
L_pc:
    s_mov_b32 s50, L_end - L_pc
    s_mov_b32 s51, 0x20000
    v_lshlrev_b32 v8, 7, v0
    s_bfe_u32 s3, s2, 65539
    s_mul_i32 s3, s3, 16384
    v_add_u32 v8, s3, v8
    buffer_load_dword v232, v8, s[48:51], 0 offen
    v_lshrrev_b32 v11, 4, v1
    v_and_b32 v8, 15, v1
    v_lshlrev_b32 v8, 6, v8
    v_lshl_add_u32 v2, v11, 4, v8
    v_lshlrev_b32 v3, 4, v1
    v_and_b32 v8, 7, v1
    v_lshlrev_b32 v8, 8, v8
    v_bfe_u32 v9, v1, 3, 1
    v_lshl_add_u32 v8, v9, 6, v8
    v_lshl_add_u32 v4, v11, 4, v8
    s_lshr_b32 s28, s28, 6
    s_mov_b32 s55, 0
    s_bfe_u32 s3, s2, 65536
    s_lshl_b32 s3, s3, 2
    s_or_b32 s55, s55, s3
    s_bfe_u32 s3, s2, 65537
    s_lshl_b32 s3, s3, 3
    s_or_b32 s55, s55, s3
    s_bfe_u32 s3, s2, 65538
    s_lshl_b32 s3, s3, 7
    s_or_b32 s55, s55, s3
    s_bfe_u32 s3, s2, 65539
    s_lshl_b32 s3, s3, 0
    s_or_b32 s55, s55, s3
    s_bfe_u32 s3, s2, 65540
    s_lshl_b32 s3, s3, 1
    s_or_b32 s55, s55, s3
    s_bfe_u32 s3, s2, 65541
    s_lshl_b32 s3, s3, 4
    s_or_b32 s55, s55, s3
    s_bfe_u32 s3, s2, 65542
    s_lshl_b32 s3, s3, 5
    s_or_b32 s55, s55, s3
    s_bfe_u32 s3, s2, 65543
    s_lshl_b32 s3, s3, 6
    s_or_b32 s55, s55, s3
    s_lshl_b32 s29, s55, 20
    s_mov_b32 s14, 0x100000
    s_mov_b32 s15, 0x20000
    s_mov_b32 s18, 0x100000
    s_mov_b32 s19, 0x20000
    s_movk_i32 s22, 2048
    s_mov_b32 s23, 0x20000
    s_movk_i32 s26, 2048
    s_mov_b32 s27, 0x20000
    s_lshl_b32 s38, s28, 13
    s_mov_b32 s34, s38
    s_add_u32 s35, s38, 4096
    s_lshl_b32 s3, s55, 11
    s_waitcnt lgkmcnt(0)
    s_add_u32 s12, s6, s29
    s_addc_u32 s13, s7, 0
    buffer_load_dwordx4 v[120:123], v2, s[12:15], s34 offen nt
    s_add_u32 s20, s4, s3
    s_addc_u32 s21, s5, 0
    s_add_u32 s16, s8, s29
    s_addc_u32 s17, s9, 0
    buffer_load_dwordx4 v[124:127], v2, s[12:15], s34 offen offset:1024 nt
    buffer_load_dwordx4 v[32:35], v4, s[20:23], 0 offen
    buffer_load_dwordx4 v[36:39], v4, s[20:23], 0 offen offset:128
    buffer_load_dwordx4 v[128:131], v2, s[12:15], s34 offen offset:2048 nt
    buffer_load_dwordx4 v[132:135], v2, s[12:15], s34 offen offset:3072 nt
    buffer_load_dwordx4 v[136:139], v2, s[12:15], s35 offen nt
    buffer_load_dwordx4 v[140:143], v2, s[12:15], s35 offen offset:1024 nt
    buffer_load_dwordx4 v[144:147], v2, s[12:15], s35 offen offset:2048 nt
    buffer_load_dwordx4 v[148:151], v2, s[12:15], s35 offen offset:3072 nt
    s_add_u32 s34, s34, 16384
    s_add_u32 s35, s35, 16384
    buffer_load_dwordx4 v[152:155], v2, s[12:15], s34 offen nt
    s_add_u32 s24, s10, s3
    s_addc_u32 s25, s11, 0
    s_mov_b32 s31, 0x3e0293ee
    s_mov_b32 s32, 0x05040100
    s_mov_b32 s33, 0x07060302
    v_mov_b32 v5, 0xff800000
    v_mov_b32 v6, 0xff800000
    v_mov_b32 v7, 0
    v_bfe_i32 v13, v1, 3, 1
    v_not_b32 v12, v13
    v_mov_b32 v56, 0
    v_mov_b32 v57, 0
    v_mov_b32 v58, 0
    v_mov_b32 v59, 0
    v_mov_b32 v60, 0
    v_mov_b32 v61, 0
    v_mov_b32 v62, 0
    v_mov_b32 v63, 0
    v_mov_b32 v64, 0
    v_mov_b32 v65, 0
    v_mov_b32 v66, 0
    v_mov_b32 v67, 0
    v_mov_b32 v68, 0
    v_mov_b32 v69, 0
    v_mov_b32 v70, 0
    v_mov_b32 v71, 0
    v_mov_b32 v72, 0
    v_mov_b32 v73, 0
    v_mov_b32 v74, 0
    v_mov_b32 v75, 0
    v_mov_b32 v76, 0
    v_mov_b32 v77, 0
    v_mov_b32 v78, 0
    v_mov_b32 v79, 0
    v_mov_b32 v80, 0
    v_mov_b32 v81, 0
    v_mov_b32 v82, 0
    v_mov_b32 v83, 0
    v_mov_b32 v84, 0
    v_mov_b32 v85, 0
    v_mov_b32 v86, 0
    v_mov_b32 v87, 0
    s_mul_i32 s29, s28, 65536
    v_lshl_add_u32 v14, v1, 4, s29
    v_lshl_add_u32 v15, v1, 4, s29
    v_mov_b32 v30, v14
    v_and_b32 v8, 7, v1
    v_lshlrev_b32 v0, 8, v8
    v_lshrrev_b32 v9, 3, v1
    v_lshl_add_u32 v0, v9, 5, v0
    s_lshl_b32 s29, s28, 4
    v_add_u32 v0, s29, v0
    s_lshl_b32 s29, s28, 6
    s_add_u32 s29, s29, 131072
    v_lshl_add_u32 v31, v8, 3, s29
    s_mov_b32 s58, 0x400000
    s_mov_b32 s59, 0x20000
    s_getreg_b32 s44, hwreg(HW_REG_XCC_ID, 0, 3)
    s_mul_i32 s44, s44, 4352
    s_add_u32 s44, s44, 0x200000
    v_add_u32 v10, s44, v1
    s_lshr_b32 s63, s2, 3
    s_lshl1_add_u32 s63, s63, s28
    s_add_u32 s63, s63, s44
    s_getreg_b32 s61, hwreg(HW_REG_XCC_ID, 0, 1)
    s_cmp_eq_u32 s61, 0
    s_cselect_b32 s61, 18, 0
    s_mov_b32 s60, 1
    s_add_u32 s62, s61, 96
    s_nop 0
    buffer_load_dwordx4 v[156:159], v2, s[12:15], s34 offen offset:1024 nt
    s_waitcnt vmcnt(11)
    buffer_load_dwordx4 v[160:163], v2, s[12:15], s34 offen offset:2048 nt
    s_waitcnt vmcnt(11)
    buffer_load_dwordx4 v[164:167], v2, s[12:15], s34 offen offset:3072 nt
    s_waitcnt vmcnt(9)
    buffer_load_dwordx4 v[168:171], v2, s[12:15], s35 offen nt
    s_waitcnt vmcnt(9)
    buffer_load_dwordx4 v[172:175], v2, s[12:15], s35 offen offset:1024 nt
    s_add_u32 s60, s60, 1
    v_mov_b32 v11, s60
    s_mov_b64 exec, 1
    buffer_store_byte v11, off, s[56:59], s63
    s_mov_b64 exec, -1
    buffer_load_ubyte v4, v10, s[56:59], 0 offen nt
    v_mfma_f32_16x16x32_bf16 v[186:189], v[120:123], v[32:35], 0
    v_mfma_f32_16x16x32_bf16 v[192:195], v[124:127], v[32:35], 0
    v_mfma_f32_16x16x32_bf16 v[198:201], v[128:131], v[32:35], 0
    s_waitcnt vmcnt(11)
    buffer_load_dwordx4 v[176:179], v2, s[12:15], s35 offen offset:2048 nt
    s_waitcnt vmcnt(11)
    buffer_load_dwordx4 v[180:183], v2, s[12:15], s35 offen offset:3072 nt
    s_add_u32 s34, s34, 16384
    s_add_u32 s35, s35, 16384
    v_mfma_f32_16x16x32_bf16 v[184:187], v[120:123], v[36:39], v[184:187]
    v_mfma_f32_16x16x32_bf16 v[204:207], v[132:135], v[32:35], 0
    v_mfma_f32_16x16x32_bf16 v[190:193], v[124:127], v[36:39], v[190:193]
    v_mfma_f32_16x16x32_bf16 v[196:199], v[128:131], v[36:39], v[196:199]
    s_waitcnt vmcnt(11)
    buffer_load_dwordx4 v[120:123], v2, s[12:15], s34 offen nt
    v_mfma_f32_16x16x32_bf16 v[210:213], v[136:139], v[32:35], 0
    s_waitcnt vmcnt(11)
    buffer_load_dwordx4 v[124:127], v2, s[12:15], s34 offen offset:1024 nt
    v_add_f32_dpp v16, v187, v186 row_ror:8 row_mask:0xf bank_mask:0x3
    v_mfma_f32_16x16x32_bf16 v[216:219], v[140:143], v[32:35], 0
    v_mfma_f32_16x16x32_bf16 v[202:205], v[132:135], v[36:39], v[202:205]
    v_add_f32_dpp v16, v192, v193 row_ror:8 row_mask:0xf bank_mask:0xc
    v_add_f32_dpp v17, v199, v198 row_ror:8 row_mask:0xf bank_mask:0x3
    s_waitcnt vmcnt(11)
    buffer_load_dwordx4 v[128:131], v2, s[12:15], s34 offen offset:2048 nt
    v_mfma_f32_16x16x32_bf16 v[222:225], v[144:147], v[32:35], 0
    v_mfma_f32_16x16x32_bf16 v[208:211], v[136:139], v[36:39], v[208:211]
    s_waitcnt vmcnt(11)
    buffer_load_dwordx4 v[132:135], v2, s[12:15], s34 offen offset:3072 nt
    v_mfma_f32_16x16x32_bf16 v[228:231], v[148:151], v[32:35], 0
    v_mfma_f32_16x16x32_bf16 v[214:217], v[140:143], v[36:39], v[214:217]
    v_add_f32_dpp v17, v204, v205 row_ror:8 row_mask:0xf bank_mask:0xc
    s_waitcnt vmcnt(11)
    buffer_load_dwordx4 v[136:139], v2, s[12:15], s35 offen nt
    v_mfma_f32_16x16x32_bf16 v[186:189], v[152:155], v[32:35], 0
    v_mfma_f32_16x16x32_bf16 v[220:223], v[144:147], v[36:39], v[220:223]
    v_add_f32_dpp v18, v211, v210 row_ror:8 row_mask:0xf bank_mask:0x3
    s_waitcnt vmcnt(11)
    buffer_load_dwordx4 v[140:143], v2, s[12:15], s35 offen offset:1024 nt
    v_mfma_f32_16x16x32_bf16 v[192:195], v[156:159], v[32:35], 0
    v_mfma_f32_16x16x32_bf16 v[226:229], v[148:151], v[36:39], v[226:229]
    v_add_f32_dpp v18, v216, v217 row_ror:8 row_mask:0xf bank_mask:0xc
    s_waitcnt vmcnt(11)
    buffer_load_dwordx4 v[144:147], v2, s[12:15], s35 offen offset:2048 nt
    v_mfma_f32_16x16x32_bf16 v[198:201], v[160:163], v[32:35], 0
    v_mfma_f32_16x16x32_bf16 v[184:187], v[152:155], v[36:39], v[184:187]
    v_add_f32_dpp v19, v223, v222 row_ror:8 row_mask:0xf bank_mask:0x3
    s_waitcnt vmcnt(11)
    buffer_load_dwordx4 v[148:151], v2, s[12:15], s35 offen offset:3072 nt
    s_add_u32 s34, s34, 16384
    s_add_u32 s35, s35, 16384
    v_mfma_f32_16x16x32_bf16 v[204:207], v[164:167], v[32:35], 0
    v_mfma_f32_16x16x32_bf16 v[190:193], v[156:159], v[36:39], v[190:193]
    v_add_f32_dpp v19, v228, v229 row_ror:8 row_mask:0xf bank_mask:0xc
    ds_write_b128 v14, v[16:19]
    v_max3_f32 v5, v16, v17, v5
    v_max3_f32 v5, v18, v19, v5
    v_add_u32 v14, 1024, v14
    s_waitcnt vmcnt(9)
    buffer_load_dwordx4 v[152:155], v2, s[12:15], s34 offen nt
    v_mfma_f32_16x16x32_bf16 v[210:213], v[168:171], v[32:35], 0
    v_mfma_f32_16x16x32_bf16 v[196:199], v[160:163], v[36:39], v[196:199]
    v_add_f32_dpp v16, v187, v186 row_ror:8 row_mask:0xf bank_mask:0x3
    s_waitcnt vmcnt(9)
    buffer_load_dwordx4 v[156:159], v2, s[12:15], s34 offen offset:1024 nt
    v_mfma_f32_16x16x32_bf16 v[216:219], v[172:175], v[32:35], 0
    v_mfma_f32_16x16x32_bf16 v[202:205], v[164:167], v[36:39], v[202:205]
    v_add_f32_dpp v16, v192, v193 row_ror:8 row_mask:0xf bank_mask:0xc
    v_mfma_f32_16x16x32_bf16 v[222:225], v[176:179], v[32:35], 0
    s_mov_b32 s30, 30
L_head_26:
    s_cmp_ge_u32 s62, 96
    s_cbranch_scc1 L_t_26_3_7
    s_cmp_ge_u32 s62, 72
    s_cbranch_scc1 L_t_26_1_3
    s_waitcnt vmcnt(8)
    buffer_load_dwordx4 v[160:163], v2, s[12:15], s34 offen offset:2048 nt
    v_mfma_f32_16x16x32_bf16 v[208:211], v[168:171], v[36:39], v[208:211]
    v_add_f32_dpp v17, v199, v198 row_ror:8 row_mask:0xf bank_mask:0x3
    v_mfma_f32_16x16x32_bf16 v[228:231], v[180:183], v[32:35], 0
    s_waitcnt vmcnt(9)
    buffer_load_dwordx4 v[164:167], v2, s[12:15], s34 offen offset:3072 nt
    v_mfma_f32_16x16x32_bf16 v[214:217], v[172:175], v[36:39], v[214:217]
    v_add_f32_dpp v17, v204, v205 row_ror:8 row_mask:0xf bank_mask:0xc
    v_mfma_f32_16x16x32_bf16 v[186:189], v[120:123], v[32:35], 0
    v_mfma_f32_16x16x32_bf16 v[220:223], v[176:179], v[36:39], v[220:223]
    s_waitcnt vmcnt(8)
    buffer_load_dwordx4 v[168:171], v2, s[12:15], s35 offen nt
    v_add_f32_dpp v18, v211, v210 row_ror:8 row_mask:0xf bank_mask:0x3
    v_mfma_f32_16x16x32_bf16 v[192:195], v[124:127], v[32:35], 0
    v_mfma_f32_16x16x32_bf16 v[226:229], v[180:183], v[36:39], v[226:229]
    s_waitcnt vmcnt(9)
    buffer_load_dwordx4 v[172:175], v2, s[12:15], s35 offen offset:1024 nt
    s_add_u32 s60, s60, 1
    v_mov_b32 v11, s60
    s_mov_b64 exec, 1
    buffer_store_byte v11, off, s[56:59], s63
    s_mov_b64 exec, -1
    buffer_load_ubyte v4, v10, s[56:59], 0 offen nt
    v_add_f32_dpp v18, v216, v217 row_ror:8 row_mask:0xf bank_mask:0xc
    v_mfma_f32_16x16x32_bf16 v[198:201], v[128:131], v[32:35], 0
    v_mfma_f32_16x16x32_bf16 v[184:187], v[120:123], v[36:39], v[184:187]
    v_add_f32_dpp v19, v223, v222 row_ror:8 row_mask:0xf bank_mask:0x3
    s_waitcnt vmcnt(10)
    buffer_load_dwordx4 v[176:179], v2, s[12:15], s35 offen offset:2048 nt
    v_mfma_f32_16x16x32_bf16 v[190:193], v[124:127], v[36:39], v[190:193]
    v_add_f32_dpp v19, v228, v229 row_ror:8 row_mask:0xf bank_mask:0xc
    ds_write_b128 v14, v[16:19]
    v_max3_f32 v5, v16, v17, v5
    v_max3_f32 v5, v18, v19, v5
    v_add_u32 v14, 1024, v14
    s_waitcnt vmcnt(11)
    buffer_load_dwordx4 v[180:183], v2, s[12:15], s35 offen offset:3072 nt
    s_add_u32 s34, s34, 16384
    s_add_u32 s35, s35, 16384
    v_mfma_f32_16x16x32_bf16 v[204:207], v[132:135], v[32:35], 0
    v_mfma_f32_16x16x32_bf16 v[196:199], v[128:131], v[36:39], v[196:199]
    v_add_f32_dpp v16, v187, v186 row_ror:8 row_mask:0xf bank_mask:0x3
    s_waitcnt vmcnt(10)
    buffer_load_dwordx4 v[120:123], v2, s[12:15], s34 offen nt
    v_mfma_f32_16x16x32_bf16 v[210:213], v[136:139], v[32:35], 0
    v_add_f32_dpp v16, v192, v193 row_ror:8 row_mask:0xf bank_mask:0xc
    s_waitcnt vmcnt(11)
    buffer_load_dwordx4 v[124:127], v2, s[12:15], s34 offen offset:1024 nt
    v_mfma_f32_16x16x32_bf16 v[216:219], v[140:143], v[32:35], 0
    v_mfma_f32_16x16x32_bf16 v[202:205], v[132:135], v[36:39], v[202:205]
    v_add_f32_dpp v17, v199, v198 row_ror:8 row_mask:0xf bank_mask:0x3
    s_waitcnt vmcnt(10)
    buffer_load_dwordx4 v[128:131], v2, s[12:15], s34 offen offset:2048 nt
    v_mfma_f32_16x16x32_bf16 v[222:225], v[144:147], v[32:35], 0
    v_mfma_f32_16x16x32_bf16 v[208:211], v[136:139], v[36:39], v[208:211]
    s_waitcnt vmcnt(11)
    buffer_load_dwordx4 v[132:135], v2, s[12:15], s34 offen offset:3072 nt
    v_mfma_f32_16x16x32_bf16 v[228:231], v[148:151], v[32:35], 0
    v_mfma_f32_16x16x32_bf16 v[214:217], v[140:143], v[36:39], v[214:217]
    v_add_f32_dpp v17, v204, v205 row_ror:8 row_mask:0xf bank_mask:0xc
    s_waitcnt vmcnt(10)
    buffer_load_dwordx4 v[136:139], v2, s[12:15], s35 offen nt
    v_mfma_f32_16x16x32_bf16 v[186:189], v[152:155], v[32:35], 0
    v_mfma_f32_16x16x32_bf16 v[220:223], v[144:147], v[36:39], v[220:223]
    v_add_f32_dpp v18, v211, v210 row_ror:8 row_mask:0xf bank_mask:0x3
    s_waitcnt vmcnt(11)
    buffer_load_dwordx4 v[140:143], v2, s[12:15], s35 offen offset:1024 nt
    v_mfma_f32_16x16x32_bf16 v[192:195], v[156:159], v[32:35], 0
    v_mfma_f32_16x16x32_bf16 v[226:229], v[148:151], v[36:39], v[226:229]
    v_add_f32_dpp v18, v216, v217 row_ror:8 row_mask:0xf bank_mask:0xc
    s_waitcnt vmcnt(10)
    buffer_load_dwordx4 v[144:147], v2, s[12:15], s35 offen offset:2048 nt
    v_mfma_f32_16x16x32_bf16 v[198:201], v[160:163], v[32:35], 0
    v_mfma_f32_16x16x32_bf16 v[184:187], v[152:155], v[36:39], v[184:187]
    v_add_f32_dpp v19, v223, v222 row_ror:8 row_mask:0xf bank_mask:0x3
    s_waitcnt vmcnt(11)
    buffer_load_dwordx4 v[148:151], v2, s[12:15], s35 offen offset:3072 nt
    s_add_u32 s34, s34, 16384
    s_add_u32 s35, s35, 16384
    v_mfma_f32_16x16x32_bf16 v[204:207], v[164:167], v[32:35], 0
    v_mfma_f32_16x16x32_bf16 v[190:193], v[156:159], v[36:39], v[190:193]
    v_add_f32_dpp v19, v228, v229 row_ror:8 row_mask:0xf bank_mask:0xc
    ds_write_b128 v14, v[16:19]
    v_max3_f32 v5, v16, v17, v5
    v_max3_f32 v5, v18, v19, v5
    v_add_u32 v14, 1024, v14
    s_waitcnt vmcnt(8)
    buffer_load_dwordx4 v[152:155], v2, s[12:15], s34 offen nt
    v_mfma_f32_16x16x32_bf16 v[210:213], v[168:171], v[32:35], 0
    v_mfma_f32_16x16x32_bf16 v[196:199], v[160:163], v[36:39], v[196:199]
    v_add_f32_dpp v16, v187, v186 row_ror:8 row_mask:0xf bank_mask:0x3
    s_waitcnt vmcnt(9)
    buffer_load_dwordx4 v[156:159], v2, s[12:15], s34 offen offset:1024 nt
    s_sub_u32 s44, s60, 1
    v_cmp_le_u32 s[64:65], s60, v4
    v_cmp_lt_u32 s[66:67], s60, v4
    v_cmp_le_u32 s[68:69], s44, v4
    s_bcnt1_i32_b64 s62, s[64:65]
    s_bcnt1_i32_b64 s44, s[66:67]
    s_add_u32 s62, s62, s61
    s_add_u32 s62, s62, s44
    s_bcnt1_i32_b64 s44, s[68:69]
    s_add_u32 s62, s62, s44
    v_mfma_f32_16x16x32_bf16 v[216:219], v[172:175], v[32:35], 0
    v_mfma_f32_16x16x32_bf16 v[202:205], v[164:167], v[36:39], v[202:205]
    v_add_f32_dpp v16, v192, v193 row_ror:8 row_mask:0xf bank_mask:0xc
    v_mfma_f32_16x16x32_bf16 v[222:225], v[176:179], v[32:35], 0
    s_sub_u32 s30, s30, 1
    s_cmp_lg_u32 s30, 0
    s_cbranch_scc1 L_head_26
    s_branch L_exit_26
L_t_26_1_3:
    s_cmp_ge_u32 s62, 84
    s_cbranch_scc1 L_t_26_2_3
    s_waitcnt vmcnt(9)
    buffer_load_dwordx4 v[160:163], v2, s[12:15], s34 offen offset:2048 nt
    v_mfma_f32_16x16x32_bf16 v[208:211], v[168:171], v[36:39], v[208:211]
    v_add_f32_dpp v17, v199, v198 row_ror:8 row_mask:0xf bank_mask:0x3
    v_mfma_f32_16x16x32_bf16 v[228:231], v[180:183], v[32:35], 0
    s_waitcnt vmcnt(9)
    buffer_load_dwordx4 v[164:167], v2, s[12:15], s34 offen offset:3072 nt
    v_mfma_f32_16x16x32_bf16 v[214:217], v[172:175], v[36:39], v[214:217]
    v_add_f32_dpp v17, v204, v205 row_ror:8 row_mask:0xf bank_mask:0xc
    v_mfma_f32_16x16x32_bf16 v[186:189], v[120:123], v[32:35], 0
    v_mfma_f32_16x16x32_bf16 v[220:223], v[176:179], v[36:39], v[220:223]
    s_waitcnt vmcnt(8)
    buffer_load_dwordx4 v[168:171], v2, s[12:15], s35 offen nt
    v_add_f32_dpp v18, v211, v210 row_ror:8 row_mask:0xf bank_mask:0x3
    v_mfma_f32_16x16x32_bf16 v[192:195], v[124:127], v[32:35], 0
    v_mfma_f32_16x16x32_bf16 v[226:229], v[180:183], v[36:39], v[226:229]
    s_waitcnt vmcnt(9)
    buffer_load_dwordx4 v[172:175], v2, s[12:15], s35 offen offset:1024 nt
    s_add_u32 s60, s60, 1
    v_mov_b32 v11, s60
    s_mov_b64 exec, 1
    buffer_store_byte v11, off, s[56:59], s63
    s_mov_b64 exec, -1
    buffer_load_ubyte v4, v10, s[56:59], 0 offen nt
    v_add_f32_dpp v18, v216, v217 row_ror:8 row_mask:0xf bank_mask:0xc
    v_mfma_f32_16x16x32_bf16 v[198:201], v[128:131], v[32:35], 0
    v_mfma_f32_16x16x32_bf16 v[184:187], v[120:123], v[36:39], v[184:187]
    v_add_f32_dpp v19, v223, v222 row_ror:8 row_mask:0xf bank_mask:0x3
    s_waitcnt vmcnt(11)
    buffer_load_dwordx4 v[176:179], v2, s[12:15], s35 offen offset:2048 nt
    v_mfma_f32_16x16x32_bf16 v[190:193], v[124:127], v[36:39], v[190:193]
    v_add_f32_dpp v19, v228, v229 row_ror:8 row_mask:0xf bank_mask:0xc
    ds_write_b128 v14, v[16:19]
    v_max3_f32 v5, v16, v17, v5
    v_max3_f32 v5, v18, v19, v5
    v_add_u32 v14, 1024, v14
    s_waitcnt vmcnt(11)
    buffer_load_dwordx4 v[180:183], v2, s[12:15], s35 offen offset:3072 nt
    s_add_u32 s34, s34, 16384
    s_add_u32 s35, s35, 16384
    v_mfma_f32_16x16x32_bf16 v[204:207], v[132:135], v[32:35], 0
    v_mfma_f32_16x16x32_bf16 v[196:199], v[128:131], v[36:39], v[196:199]
    v_add_f32_dpp v16, v187, v186 row_ror:8 row_mask:0xf bank_mask:0x3
    s_waitcnt vmcnt(10)
    buffer_load_dwordx4 v[120:123], v2, s[12:15], s34 offen nt
    v_mfma_f32_16x16x32_bf16 v[210:213], v[136:139], v[32:35], 0
    v_add_f32_dpp v16, v192, v193 row_ror:8 row_mask:0xf bank_mask:0xc
    s_waitcnt vmcnt(11)
    buffer_load_dwordx4 v[124:127], v2, s[12:15], s34 offen offset:1024 nt
    v_mfma_f32_16x16x32_bf16 v[216:219], v[140:143], v[32:35], 0
    v_mfma_f32_16x16x32_bf16 v[202:205], v[132:135], v[36:39], v[202:205]
    v_add_f32_dpp v17, v199, v198 row_ror:8 row_mask:0xf bank_mask:0x3
    s_waitcnt vmcnt(11)
    buffer_load_dwordx4 v[128:131], v2, s[12:15], s34 offen offset:2048 nt
    v_mfma_f32_16x16x32_bf16 v[222:225], v[144:147], v[32:35], 0
    v_mfma_f32_16x16x32_bf16 v[208:211], v[136:139], v[36:39], v[208:211]
    s_waitcnt vmcnt(11)
    buffer_load_dwordx4 v[132:135], v2, s[12:15], s34 offen offset:3072 nt
    v_mfma_f32_16x16x32_bf16 v[228:231], v[148:151], v[32:35], 0
    v_mfma_f32_16x16x32_bf16 v[214:217], v[140:143], v[36:39], v[214:217]
    v_add_f32_dpp v17, v204, v205 row_ror:8 row_mask:0xf bank_mask:0xc
    s_waitcnt vmcnt(10)
    buffer_load_dwordx4 v[136:139], v2, s[12:15], s35 offen nt
    v_mfma_f32_16x16x32_bf16 v[186:189], v[152:155], v[32:35], 0
    v_mfma_f32_16x16x32_bf16 v[220:223], v[144:147], v[36:39], v[220:223]
    v_add_f32_dpp v18, v211, v210 row_ror:8 row_mask:0xf bank_mask:0x3
    s_waitcnt vmcnt(11)
    buffer_load_dwordx4 v[140:143], v2, s[12:15], s35 offen offset:1024 nt
    v_mfma_f32_16x16x32_bf16 v[192:195], v[156:159], v[32:35], 0
    v_mfma_f32_16x16x32_bf16 v[226:229], v[148:151], v[36:39], v[226:229]
    v_add_f32_dpp v18, v216, v217 row_ror:8 row_mask:0xf bank_mask:0xc
    s_waitcnt vmcnt(11)
    buffer_load_dwordx4 v[144:147], v2, s[12:15], s35 offen offset:2048 nt
    v_mfma_f32_16x16x32_bf16 v[198:201], v[160:163], v[32:35], 0
    v_mfma_f32_16x16x32_bf16 v[184:187], v[152:155], v[36:39], v[184:187]
    v_add_f32_dpp v19, v223, v222 row_ror:8 row_mask:0xf bank_mask:0x3
    s_waitcnt vmcnt(11)
    buffer_load_dwordx4 v[148:151], v2, s[12:15], s35 offen offset:3072 nt
    s_add_u32 s34, s34, 16384
    s_add_u32 s35, s35, 16384
    v_mfma_f32_16x16x32_bf16 v[204:207], v[164:167], v[32:35], 0
    v_mfma_f32_16x16x32_bf16 v[190:193], v[156:159], v[36:39], v[190:193]
    v_add_f32_dpp v19, v228, v229 row_ror:8 row_mask:0xf bank_mask:0xc
    ds_write_b128 v14, v[16:19]
    v_max3_f32 v5, v16, v17, v5
    v_max3_f32 v5, v18, v19, v5
    v_add_u32 v14, 1024, v14
    s_waitcnt vmcnt(8)
    buffer_load_dwordx4 v[152:155], v2, s[12:15], s34 offen nt
    v_mfma_f32_16x16x32_bf16 v[210:213], v[168:171], v[32:35], 0
    v_mfma_f32_16x16x32_bf16 v[196:199], v[160:163], v[36:39], v[196:199]
    v_add_f32_dpp v16, v187, v186 row_ror:8 row_mask:0xf bank_mask:0x3
    s_waitcnt vmcnt(9)
    buffer_load_dwordx4 v[156:159], v2, s[12:15], s34 offen offset:1024 nt
    s_sub_u32 s44, s60, 1
    v_cmp_le_u32 s[64:65], s60, v4
    v_cmp_lt_u32 s[66:67], s60, v4
    v_cmp_le_u32 s[68:69], s44, v4
    s_bcnt1_i32_b64 s62, s[64:65]
    s_bcnt1_i32_b64 s44, s[66:67]
    s_add_u32 s62, s62, s61
    s_add_u32 s62, s62, s44
    s_bcnt1_i32_b64 s44, s[68:69]
    s_add_u32 s62, s62, s44
    v_mfma_f32_16x16x32_bf16 v[216:219], v[172:175], v[32:35], 0
    v_mfma_f32_16x16x32_bf16 v[202:205], v[164:167], v[36:39], v[202:205]
    v_add_f32_dpp v16, v192, v193 row_ror:8 row_mask:0xf bank_mask:0xc
    v_mfma_f32_16x16x32_bf16 v[222:225], v[176:179], v[32:35], 0
    s_sub_u32 s30, s30, 1
    s_cmp_lg_u32 s30, 0
    s_cbranch_scc1 L_head_26
    s_branch L_exit_26
L_t_26_2_3:
    s_waitcnt vmcnt(9)
    buffer_load_dwordx4 v[160:163], v2, s[12:15], s34 offen offset:2048 nt
    v_mfma_f32_16x16x32_bf16 v[208:211], v[168:171], v[36:39], v[208:211]
    v_add_f32_dpp v17, v199, v198 row_ror:8 row_mask:0xf bank_mask:0x3
    v_mfma_f32_16x16x32_bf16 v[228:231], v[180:183], v[32:35], 0
    s_waitcnt vmcnt(9)
    buffer_load_dwordx4 v[164:167], v2, s[12:15], s34 offen offset:3072 nt
    v_mfma_f32_16x16x32_bf16 v[214:217], v[172:175], v[36:39], v[214:217]
    v_add_f32_dpp v17, v204, v205 row_ror:8 row_mask:0xf bank_mask:0xc
    v_mfma_f32_16x16x32_bf16 v[186:189], v[120:123], v[32:35], 0
    v_mfma_f32_16x16x32_bf16 v[220:223], v[176:179], v[36:39], v[220:223]
    s_waitcnt vmcnt(9)
    buffer_load_dwordx4 v[168:171], v2, s[12:15], s35 offen nt
    v_add_f32_dpp v18, v211, v210 row_ror:8 row_mask:0xf bank_mask:0x3
    v_mfma_f32_16x16x32_bf16 v[192:195], v[124:127], v[32:35], 0
    v_mfma_f32_16x16x32_bf16 v[226:229], v[180:183], v[36:39], v[226:229]
    s_waitcnt vmcnt(9)
    buffer_load_dwordx4 v[172:175], v2, s[12:15], s35 offen offset:1024 nt
    s_add_u32 s60, s60, 1
    v_mov_b32 v11, s60
    s_mov_b64 exec, 1
    buffer_store_byte v11, off, s[56:59], s63
    s_mov_b64 exec, -1
    buffer_load_ubyte v4, v10, s[56:59], 0 offen nt
    v_add_f32_dpp v18, v216, v217 row_ror:8 row_mask:0xf bank_mask:0xc
    v_mfma_f32_16x16x32_bf16 v[198:201], v[128:131], v[32:35], 0
    v_mfma_f32_16x16x32_bf16 v[184:187], v[120:123], v[36:39], v[184:187]
    v_add_f32_dpp v19, v223, v222 row_ror:8 row_mask:0xf bank_mask:0x3
    s_waitcnt vmcnt(11)
    buffer_load_dwordx4 v[176:179], v2, s[12:15], s35 offen offset:2048 nt
    v_mfma_f32_16x16x32_bf16 v[190:193], v[124:127], v[36:39], v[190:193]
    v_add_f32_dpp v19, v228, v229 row_ror:8 row_mask:0xf bank_mask:0xc
    ds_write_b128 v14, v[16:19]
    v_max3_f32 v5, v16, v17, v5
    v_max3_f32 v5, v18, v19, v5
    v_add_u32 v14, 1024, v14
    s_waitcnt vmcnt(11)
    buffer_load_dwordx4 v[180:183], v2, s[12:15], s35 offen offset:3072 nt
    s_add_u32 s34, s34, 16384
    s_add_u32 s35, s35, 16384
    v_mfma_f32_16x16x32_bf16 v[204:207], v[132:135], v[32:35], 0
    v_mfma_f32_16x16x32_bf16 v[196:199], v[128:131], v[36:39], v[196:199]
    v_add_f32_dpp v16, v187, v186 row_ror:8 row_mask:0xf bank_mask:0x3
    s_waitcnt vmcnt(11)
    buffer_load_dwordx4 v[120:123], v2, s[12:15], s34 offen nt
    v_mfma_f32_16x16x32_bf16 v[210:213], v[136:139], v[32:35], 0
    v_add_f32_dpp v16, v192, v193 row_ror:8 row_mask:0xf bank_mask:0xc
    s_waitcnt vmcnt(11)
    buffer_load_dwordx4 v[124:127], v2, s[12:15], s34 offen offset:1024 nt
    v_mfma_f32_16x16x32_bf16 v[216:219], v[140:143], v[32:35], 0
    v_mfma_f32_16x16x32_bf16 v[202:205], v[132:135], v[36:39], v[202:205]
    v_add_f32_dpp v17, v199, v198 row_ror:8 row_mask:0xf bank_mask:0x3
    s_waitcnt vmcnt(11)
    buffer_load_dwordx4 v[128:131], v2, s[12:15], s34 offen offset:2048 nt
    v_mfma_f32_16x16x32_bf16 v[222:225], v[144:147], v[32:35], 0
    v_mfma_f32_16x16x32_bf16 v[208:211], v[136:139], v[36:39], v[208:211]
    s_waitcnt vmcnt(11)
    buffer_load_dwordx4 v[132:135], v2, s[12:15], s34 offen offset:3072 nt
    v_mfma_f32_16x16x32_bf16 v[228:231], v[148:151], v[32:35], 0
    v_mfma_f32_16x16x32_bf16 v[214:217], v[140:143], v[36:39], v[214:217]
    v_add_f32_dpp v17, v204, v205 row_ror:8 row_mask:0xf bank_mask:0xc
    s_waitcnt vmcnt(11)
    buffer_load_dwordx4 v[136:139], v2, s[12:15], s35 offen nt
    v_mfma_f32_16x16x32_bf16 v[186:189], v[152:155], v[32:35], 0
    v_mfma_f32_16x16x32_bf16 v[220:223], v[144:147], v[36:39], v[220:223]
    v_add_f32_dpp v18, v211, v210 row_ror:8 row_mask:0xf bank_mask:0x3
    s_waitcnt vmcnt(11)
    buffer_load_dwordx4 v[140:143], v2, s[12:15], s35 offen offset:1024 nt
    v_mfma_f32_16x16x32_bf16 v[192:195], v[156:159], v[32:35], 0
    v_mfma_f32_16x16x32_bf16 v[226:229], v[148:151], v[36:39], v[226:229]
    v_add_f32_dpp v18, v216, v217 row_ror:8 row_mask:0xf bank_mask:0xc
    s_waitcnt vmcnt(11)
    buffer_load_dwordx4 v[144:147], v2, s[12:15], s35 offen offset:2048 nt
    v_mfma_f32_16x16x32_bf16 v[198:201], v[160:163], v[32:35], 0
    v_mfma_f32_16x16x32_bf16 v[184:187], v[152:155], v[36:39], v[184:187]
    v_add_f32_dpp v19, v223, v222 row_ror:8 row_mask:0xf bank_mask:0x3
    s_waitcnt vmcnt(11)
    buffer_load_dwordx4 v[148:151], v2, s[12:15], s35 offen offset:3072 nt
    s_add_u32 s34, s34, 16384
    s_add_u32 s35, s35, 16384
    v_mfma_f32_16x16x32_bf16 v[204:207], v[164:167], v[32:35], 0
    v_mfma_f32_16x16x32_bf16 v[190:193], v[156:159], v[36:39], v[190:193]
    v_add_f32_dpp v19, v228, v229 row_ror:8 row_mask:0xf bank_mask:0xc
    ds_write_b128 v14, v[16:19]
    v_max3_f32 v5, v16, v17, v5
    v_max3_f32 v5, v18, v19, v5
    v_add_u32 v14, 1024, v14
    s_waitcnt vmcnt(9)
    buffer_load_dwordx4 v[152:155], v2, s[12:15], s34 offen nt
    v_mfma_f32_16x16x32_bf16 v[210:213], v[168:171], v[32:35], 0
    v_mfma_f32_16x16x32_bf16 v[196:199], v[160:163], v[36:39], v[196:199]
    v_add_f32_dpp v16, v187, v186 row_ror:8 row_mask:0xf bank_mask:0x3
    s_waitcnt vmcnt(9)
    buffer_load_dwordx4 v[156:159], v2, s[12:15], s34 offen offset:1024 nt
    s_sub_u32 s44, s60, 1
    v_cmp_le_u32 s[64:65], s60, v4
    v_cmp_lt_u32 s[66:67], s60, v4
    v_cmp_le_u32 s[68:69], s44, v4
    s_bcnt1_i32_b64 s62, s[64:65]
    s_bcnt1_i32_b64 s44, s[66:67]
    s_add_u32 s62, s62, s61
    s_add_u32 s62, s62, s44
    s_bcnt1_i32_b64 s44, s[68:69]
    s_add_u32 s62, s62, s44
    v_mfma_f32_16x16x32_bf16 v[216:219], v[172:175], v[32:35], 0
    v_mfma_f32_16x16x32_bf16 v[202:205], v[164:167], v[36:39], v[202:205]
    v_add_f32_dpp v16, v192, v193 row_ror:8 row_mask:0xf bank_mask:0xc
    v_mfma_f32_16x16x32_bf16 v[222:225], v[176:179], v[32:35], 0
    s_sub_u32 s30, s30, 1
    s_cmp_lg_u32 s30, 0
    s_cbranch_scc1 L_head_26
    s_branch L_exit_26
L_t_26_3_7:
    s_cmp_ge_u32 s62, 120
    s_cbranch_scc1 L_t_26_5_7
    s_cmp_ge_u32 s62, 108
    s_cbranch_scc1 L_t_26_4_5
    s_waitcnt vmcnt(9)
    buffer_load_dwordx4 v[160:163], v2, s[12:15], s34 offen offset:2048 nt
    v_mfma_f32_16x16x32_bf16 v[208:211], v[168:171], v[36:39], v[208:211]
    v_add_f32_dpp v17, v199, v198 row_ror:8 row_mask:0xf bank_mask:0x3
    v_mfma_f32_16x16x32_bf16 v[228:231], v[180:183], v[32:35], 0
    s_waitcnt vmcnt(10)
    buffer_load_dwordx4 v[164:167], v2, s[12:15], s34 offen offset:3072 nt
    v_mfma_f32_16x16x32_bf16 v[214:217], v[172:175], v[36:39], v[214:217]
    v_add_f32_dpp v17, v204, v205 row_ror:8 row_mask:0xf bank_mask:0xc
    v_mfma_f32_16x16x32_bf16 v[186:189], v[120:123], v[32:35], 0
    v_mfma_f32_16x16x32_bf16 v[220:223], v[176:179], v[36:39], v[220:223]
    s_waitcnt vmcnt(9)
    buffer_load_dwordx4 v[168:171], v2, s[12:15], s35 offen nt
    v_add_f32_dpp v18, v211, v210 row_ror:8 row_mask:0xf bank_mask:0x3
    v_mfma_f32_16x16x32_bf16 v[192:195], v[124:127], v[32:35], 0
    v_mfma_f32_16x16x32_bf16 v[226:229], v[180:183], v[36:39], v[226:229]
    s_waitcnt vmcnt(9)
    buffer_load_dwordx4 v[172:175], v2, s[12:15], s35 offen offset:1024 nt
    s_add_u32 s60, s60, 1
    v_mov_b32 v11, s60
    s_mov_b64 exec, 1
    buffer_store_byte v11, off, s[56:59], s63
    s_mov_b64 exec, -1
    buffer_load_ubyte v4, v10, s[56:59], 0 offen nt
    v_add_f32_dpp v18, v216, v217 row_ror:8 row_mask:0xf bank_mask:0xc
    v_mfma_f32_16x16x32_bf16 v[198:201], v[128:131], v[32:35], 0
    v_mfma_f32_16x16x32_bf16 v[184:187], v[120:123], v[36:39], v[184:187]
    v_add_f32_dpp v19, v223, v222 row_ror:8 row_mask:0xf bank_mask:0x3
    s_waitcnt vmcnt(11)
    buffer_load_dwordx4 v[176:179], v2, s[12:15], s35 offen offset:2048 nt
    v_mfma_f32_16x16x32_bf16 v[190:193], v[124:127], v[36:39], v[190:193]
    v_add_f32_dpp v19, v228, v229 row_ror:8 row_mask:0xf bank_mask:0xc
    ds_write_b128 v14, v[16:19]
    v_max3_f32 v5, v16, v17, v5
    v_max3_f32 v5, v18, v19, v5
    v_add_u32 v14, 1024, v14
    s_waitcnt vmcnt(12)
    buffer_load_dwordx4 v[180:183], v2, s[12:15], s35 offen offset:3072 nt
    s_add_u32 s34, s34, 16384
    s_add_u32 s35, s35, 16384
    v_mfma_f32_16x16x32_bf16 v[204:207], v[132:135], v[32:35], 0
    v_mfma_f32_16x16x32_bf16 v[196:199], v[128:131], v[36:39], v[196:199]
    v_add_f32_dpp v16, v187, v186 row_ror:8 row_mask:0xf bank_mask:0x3
    s_waitcnt vmcnt(11)
    buffer_load_dwordx4 v[120:123], v2, s[12:15], s34 offen nt
    v_mfma_f32_16x16x32_bf16 v[210:213], v[136:139], v[32:35], 0
    v_add_f32_dpp v16, v192, v193 row_ror:8 row_mask:0xf bank_mask:0xc
    s_waitcnt vmcnt(11)
    buffer_load_dwordx4 v[124:127], v2, s[12:15], s34 offen offset:1024 nt
    v_mfma_f32_16x16x32_bf16 v[216:219], v[140:143], v[32:35], 0
    v_mfma_f32_16x16x32_bf16 v[202:205], v[132:135], v[36:39], v[202:205]
    v_add_f32_dpp v17, v199, v198 row_ror:8 row_mask:0xf bank_mask:0x3
    s_waitcnt vmcnt(11)
    buffer_load_dwordx4 v[128:131], v2, s[12:15], s34 offen offset:2048 nt
    v_mfma_f32_16x16x32_bf16 v[222:225], v[144:147], v[32:35], 0
    v_mfma_f32_16x16x32_bf16 v[208:211], v[136:139], v[36:39], v[208:211]
    s_waitcnt vmcnt(12)
    buffer_load_dwordx4 v[132:135], v2, s[12:15], s34 offen offset:3072 nt
    v_mfma_f32_16x16x32_bf16 v[228:231], v[148:151], v[32:35], 0
    v_mfma_f32_16x16x32_bf16 v[214:217], v[140:143], v[36:39], v[214:217]
    v_add_f32_dpp v17, v204, v205 row_ror:8 row_mask:0xf bank_mask:0xc
    s_waitcnt vmcnt(11)
    buffer_load_dwordx4 v[136:139], v2, s[12:15], s35 offen nt
    v_mfma_f32_16x16x32_bf16 v[186:189], v[152:155], v[32:35], 0
    v_mfma_f32_16x16x32_bf16 v[220:223], v[144:147], v[36:39], v[220:223]
    v_add_f32_dpp v18, v211, v210 row_ror:8 row_mask:0xf bank_mask:0x3
    s_waitcnt vmcnt(11)
    buffer_load_dwordx4 v[140:143], v2, s[12:15], s35 offen offset:1024 nt
    v_mfma_f32_16x16x32_bf16 v[192:195], v[156:159], v[32:35], 0
    v_mfma_f32_16x16x32_bf16 v[226:229], v[148:151], v[36:39], v[226:229]
    v_add_f32_dpp v18, v216, v217 row_ror:8 row_mask:0xf bank_mask:0xc
    s_waitcnt vmcnt(11)
    buffer_load_dwordx4 v[144:147], v2, s[12:15], s35 offen offset:2048 nt
    v_mfma_f32_16x16x32_bf16 v[198:201], v[160:163], v[32:35], 0
    v_mfma_f32_16x16x32_bf16 v[184:187], v[152:155], v[36:39], v[184:187]
    v_add_f32_dpp v19, v223, v222 row_ror:8 row_mask:0xf bank_mask:0x3
    s_waitcnt vmcnt(12)
    buffer_load_dwordx4 v[148:151], v2, s[12:15], s35 offen offset:3072 nt
    s_add_u32 s34, s34, 16384
    s_add_u32 s35, s35, 16384
    v_mfma_f32_16x16x32_bf16 v[204:207], v[164:167], v[32:35], 0
    v_mfma_f32_16x16x32_bf16 v[190:193], v[156:159], v[36:39], v[190:193]
    v_add_f32_dpp v19, v228, v229 row_ror:8 row_mask:0xf bank_mask:0xc
    ds_write_b128 v14, v[16:19]
    v_max3_f32 v5, v16, v17, v5
    v_max3_f32 v5, v18, v19, v5
    v_add_u32 v14, 1024, v14
    s_waitcnt vmcnt(9)
    buffer_load_dwordx4 v[152:155], v2, s[12:15], s34 offen nt
    v_mfma_f32_16x16x32_bf16 v[210:213], v[168:171], v[32:35], 0
    v_mfma_f32_16x16x32_bf16 v[196:199], v[160:163], v[36:39], v[196:199]
    v_add_f32_dpp v16, v187, v186 row_ror:8 row_mask:0xf bank_mask:0x3
    s_waitcnt vmcnt(9)
    buffer_load_dwordx4 v[156:159], v2, s[12:15], s34 offen offset:1024 nt
    s_sub_u32 s44, s60, 1
    v_cmp_le_u32 s[64:65], s60, v4
    v_cmp_lt_u32 s[66:67], s60, v4
    v_cmp_le_u32 s[68:69], s44, v4
    s_bcnt1_i32_b64 s62, s[64:65]
    s_bcnt1_i32_b64 s44, s[66:67]
    s_add_u32 s62, s62, s61
    s_add_u32 s62, s62, s44
    s_bcnt1_i32_b64 s44, s[68:69]
    s_add_u32 s62, s62, s44
    v_mfma_f32_16x16x32_bf16 v[216:219], v[172:175], v[32:35], 0
    v_mfma_f32_16x16x32_bf16 v[202:205], v[164:167], v[36:39], v[202:205]
    v_add_f32_dpp v16, v192, v193 row_ror:8 row_mask:0xf bank_mask:0xc
    v_mfma_f32_16x16x32_bf16 v[222:225], v[176:179], v[32:35], 0
    s_sub_u32 s30, s30, 1
    s_cmp_lg_u32 s30, 0
    s_cbranch_scc1 L_head_26
    s_branch L_exit_26
L_t_26_4_5:
    s_waitcnt vmcnt(9)
    buffer_load_dwordx4 v[160:163], v2, s[12:15], s34 offen offset:2048 nt
    v_mfma_f32_16x16x32_bf16 v[208:211], v[168:171], v[36:39], v[208:211]
    v_add_f32_dpp v17, v199, v198 row_ror:8 row_mask:0xf bank_mask:0x3
    v_mfma_f32_16x16x32_bf16 v[228:231], v[180:183], v[32:35], 0
    s_waitcnt vmcnt(10)
    buffer_load_dwordx4 v[164:167], v2, s[12:15], s34 offen offset:3072 nt
    v_mfma_f32_16x16x32_bf16 v[214:217], v[172:175], v[36:39], v[214:217]
    v_add_f32_dpp v17, v204, v205 row_ror:8 row_mask:0xf bank_mask:0xc
    v_mfma_f32_16x16x32_bf16 v[186:189], v[120:123], v[32:35], 0
    v_mfma_f32_16x16x32_bf16 v[220:223], v[176:179], v[36:39], v[220:223]
    s_waitcnt vmcnt(9)
    buffer_load_dwordx4 v[168:171], v2, s[12:15], s35 offen nt
    v_add_f32_dpp v18, v211, v210 row_ror:8 row_mask:0xf bank_mask:0x3
    v_mfma_f32_16x16x32_bf16 v[192:195], v[124:127], v[32:35], 0
    v_mfma_f32_16x16x32_bf16 v[226:229], v[180:183], v[36:39], v[226:229]
    s_waitcnt vmcnt(10)
    buffer_load_dwordx4 v[172:175], v2, s[12:15], s35 offen offset:1024 nt
    s_add_u32 s60, s60, 1
    v_mov_b32 v11, s60
    s_mov_b64 exec, 1
    buffer_store_byte v11, off, s[56:59], s63
    s_mov_b64 exec, -1
    buffer_load_ubyte v4, v10, s[56:59], 0 offen nt
    v_add_f32_dpp v18, v216, v217 row_ror:8 row_mask:0xf bank_mask:0xc
    v_mfma_f32_16x16x32_bf16 v[198:201], v[128:131], v[32:35], 0
    v_mfma_f32_16x16x32_bf16 v[184:187], v[120:123], v[36:39], v[184:187]
    v_add_f32_dpp v19, v223, v222 row_ror:8 row_mask:0xf bank_mask:0x3
    s_waitcnt vmcnt(11)
    buffer_load_dwordx4 v[176:179], v2, s[12:15], s35 offen offset:2048 nt
    v_mfma_f32_16x16x32_bf16 v[190:193], v[124:127], v[36:39], v[190:193]
    v_add_f32_dpp v19, v228, v229 row_ror:8 row_mask:0xf bank_mask:0xc
    ds_write_b128 v14, v[16:19]
    v_max3_f32 v5, v16, v17, v5
    v_max3_f32 v5, v18, v19, v5
    v_add_u32 v14, 1024, v14
    s_waitcnt vmcnt(12)
    buffer_load_dwordx4 v[180:183], v2, s[12:15], s35 offen offset:3072 nt
    s_add_u32 s34, s34, 16384
    s_add_u32 s35, s35, 16384
    v_mfma_f32_16x16x32_bf16 v[204:207], v[132:135], v[32:35], 0
    v_mfma_f32_16x16x32_bf16 v[196:199], v[128:131], v[36:39], v[196:199]
    v_add_f32_dpp v16, v187, v186 row_ror:8 row_mask:0xf bank_mask:0x3
    s_waitcnt vmcnt(11)
    buffer_load_dwordx4 v[120:123], v2, s[12:15], s34 offen nt
    v_mfma_f32_16x16x32_bf16 v[210:213], v[136:139], v[32:35], 0
    v_add_f32_dpp v16, v192, v193 row_ror:8 row_mask:0xf bank_mask:0xc
    s_waitcnt vmcnt(12)
    buffer_load_dwordx4 v[124:127], v2, s[12:15], s34 offen offset:1024 nt
    v_mfma_f32_16x16x32_bf16 v[216:219], v[140:143], v[32:35], 0
    v_mfma_f32_16x16x32_bf16 v[202:205], v[132:135], v[36:39], v[202:205]
    v_add_f32_dpp v17, v199, v198 row_ror:8 row_mask:0xf bank_mask:0x3
    s_waitcnt vmcnt(11)
    buffer_load_dwordx4 v[128:131], v2, s[12:15], s34 offen offset:2048 nt
    v_mfma_f32_16x16x32_bf16 v[222:225], v[144:147], v[32:35], 0
    v_mfma_f32_16x16x32_bf16 v[208:211], v[136:139], v[36:39], v[208:211]
    s_waitcnt vmcnt(12)
    buffer_load_dwordx4 v[132:135], v2, s[12:15], s34 offen offset:3072 nt
    v_mfma_f32_16x16x32_bf16 v[228:231], v[148:151], v[32:35], 0
    v_mfma_f32_16x16x32_bf16 v[214:217], v[140:143], v[36:39], v[214:217]
    v_add_f32_dpp v17, v204, v205 row_ror:8 row_mask:0xf bank_mask:0xc
    s_waitcnt vmcnt(11)
    buffer_load_dwordx4 v[136:139], v2, s[12:15], s35 offen nt
    v_mfma_f32_16x16x32_bf16 v[186:189], v[152:155], v[32:35], 0
    v_mfma_f32_16x16x32_bf16 v[220:223], v[144:147], v[36:39], v[220:223]
    v_add_f32_dpp v18, v211, v210 row_ror:8 row_mask:0xf bank_mask:0x3
    s_waitcnt vmcnt(12)
    buffer_load_dwordx4 v[140:143], v2, s[12:15], s35 offen offset:1024 nt
    v_mfma_f32_16x16x32_bf16 v[192:195], v[156:159], v[32:35], 0
    v_mfma_f32_16x16x32_bf16 v[226:229], v[148:151], v[36:39], v[226:229]
    v_add_f32_dpp v18, v216, v217 row_ror:8 row_mask:0xf bank_mask:0xc
    s_waitcnt vmcnt(11)
    buffer_load_dwordx4 v[144:147], v2, s[12:15], s35 offen offset:2048 nt
    v_mfma_f32_16x16x32_bf16 v[198:201], v[160:163], v[32:35], 0
    v_mfma_f32_16x16x32_bf16 v[184:187], v[152:155], v[36:39], v[184:187]
    v_add_f32_dpp v19, v223, v222 row_ror:8 row_mask:0xf bank_mask:0x3
    s_waitcnt vmcnt(12)
    buffer_load_dwordx4 v[148:151], v2, s[12:15], s35 offen offset:3072 nt
    s_add_u32 s34, s34, 16384
    s_add_u32 s35, s35, 16384
    v_mfma_f32_16x16x32_bf16 v[204:207], v[164:167], v[32:35], 0
    v_mfma_f32_16x16x32_bf16 v[190:193], v[156:159], v[36:39], v[190:193]
    v_add_f32_dpp v19, v228, v229 row_ror:8 row_mask:0xf bank_mask:0xc
    ds_write_b128 v14, v[16:19]
    v_max3_f32 v5, v16, v17, v5
    v_max3_f32 v5, v18, v19, v5
    v_add_u32 v14, 1024, v14
    s_waitcnt vmcnt(9)
    buffer_load_dwordx4 v[152:155], v2, s[12:15], s34 offen nt
    v_mfma_f32_16x16x32_bf16 v[210:213], v[168:171], v[32:35], 0
    v_mfma_f32_16x16x32_bf16 v[196:199], v[160:163], v[36:39], v[196:199]
    v_add_f32_dpp v16, v187, v186 row_ror:8 row_mask:0xf bank_mask:0x3
    s_waitcnt vmcnt(10)
    buffer_load_dwordx4 v[156:159], v2, s[12:15], s34 offen offset:1024 nt
    s_sub_u32 s44, s60, 1
    v_cmp_le_u32 s[64:65], s60, v4
    v_cmp_lt_u32 s[66:67], s60, v4
    v_cmp_le_u32 s[68:69], s44, v4
    s_bcnt1_i32_b64 s62, s[64:65]
    s_bcnt1_i32_b64 s44, s[66:67]
    s_add_u32 s62, s62, s61
    s_add_u32 s62, s62, s44
    s_bcnt1_i32_b64 s44, s[68:69]
    s_add_u32 s62, s62, s44
    v_mfma_f32_16x16x32_bf16 v[216:219], v[172:175], v[32:35], 0
    v_mfma_f32_16x16x32_bf16 v[202:205], v[164:167], v[36:39], v[202:205]
    v_add_f32_dpp v16, v192, v193 row_ror:8 row_mask:0xf bank_mask:0xc
    v_mfma_f32_16x16x32_bf16 v[222:225], v[176:179], v[32:35], 0
    s_sub_u32 s30, s30, 1
    s_cmp_lg_u32 s30, 0
    s_cbranch_scc1 L_head_26
    s_branch L_exit_26
L_t_26_5_7:
    s_cmp_ge_u32 s62, 132
    s_cbranch_scc1 L_t_26_6_7
    s_waitcnt vmcnt(10)
    buffer_load_dwordx4 v[160:163], v2, s[12:15], s34 offen offset:2048 nt
    v_mfma_f32_16x16x32_bf16 v[208:211], v[168:171], v[36:39], v[208:211]
    v_add_f32_dpp v17, v199, v198 row_ror:8 row_mask:0xf bank_mask:0x3
    v_mfma_f32_16x16x32_bf16 v[228:231], v[180:183], v[32:35], 0
    s_waitcnt vmcnt(10)
    buffer_load_dwordx4 v[164:167], v2, s[12:15], s34 offen offset:3072 nt
    v_mfma_f32_16x16x32_bf16 v[214:217], v[172:175], v[36:39], v[214:217]
    v_add_f32_dpp v17, v204, v205 row_ror:8 row_mask:0xf bank_mask:0xc
    v_mfma_f32_16x16x32_bf16 v[186:189], v[120:123], v[32:35], 0
    v_mfma_f32_16x16x32_bf16 v[220:223], v[176:179], v[36:39], v[220:223]
    s_waitcnt vmcnt(9)
    buffer_load_dwordx4 v[168:171], v2, s[12:15], s35 offen nt
    v_add_f32_dpp v18, v211, v210 row_ror:8 row_mask:0xf bank_mask:0x3
    v_mfma_f32_16x16x32_bf16 v[192:195], v[124:127], v[32:35], 0
    v_mfma_f32_16x16x32_bf16 v[226:229], v[180:183], v[36:39], v[226:229]
    s_waitcnt vmcnt(10)
    buffer_load_dwordx4 v[172:175], v2, s[12:15], s35 offen offset:1024 nt
    s_add_u32 s60, s60, 1
    v_mov_b32 v11, s60
    s_mov_b64 exec, 1
    buffer_store_byte v11, off, s[56:59], s63
    s_mov_b64 exec, -1
    buffer_load_ubyte v4, v10, s[56:59], 0 offen nt
    v_add_f32_dpp v18, v216, v217 row_ror:8 row_mask:0xf bank_mask:0xc
    v_mfma_f32_16x16x32_bf16 v[198:201], v[128:131], v[32:35], 0
    v_mfma_f32_16x16x32_bf16 v[184:187], v[120:123], v[36:39], v[184:187]
    v_add_f32_dpp v19, v223, v222 row_ror:8 row_mask:0xf bank_mask:0x3
    s_waitcnt vmcnt(12)
    buffer_load_dwordx4 v[176:179], v2, s[12:15], s35 offen offset:2048 nt
    v_mfma_f32_16x16x32_bf16 v[190:193], v[124:127], v[36:39], v[190:193]
    v_add_f32_dpp v19, v228, v229 row_ror:8 row_mask:0xf bank_mask:0xc
    ds_write_b128 v14, v[16:19]
    v_max3_f32 v5, v16, v17, v5
    v_max3_f32 v5, v18, v19, v5
    v_add_u32 v14, 1024, v14
    s_waitcnt vmcnt(12)
    buffer_load_dwordx4 v[180:183], v2, s[12:15], s35 offen offset:3072 nt
    s_add_u32 s34, s34, 16384
    s_add_u32 s35, s35, 16384
    v_mfma_f32_16x16x32_bf16 v[204:207], v[132:135], v[32:35], 0
    v_mfma_f32_16x16x32_bf16 v[196:199], v[128:131], v[36:39], v[196:199]
    v_add_f32_dpp v16, v187, v186 row_ror:8 row_mask:0xf bank_mask:0x3
    s_waitcnt vmcnt(11)
    buffer_load_dwordx4 v[120:123], v2, s[12:15], s34 offen nt
    v_mfma_f32_16x16x32_bf16 v[210:213], v[136:139], v[32:35], 0
    v_add_f32_dpp v16, v192, v193 row_ror:8 row_mask:0xf bank_mask:0xc
    s_waitcnt vmcnt(12)
    buffer_load_dwordx4 v[124:127], v2, s[12:15], s34 offen offset:1024 nt
    v_mfma_f32_16x16x32_bf16 v[216:219], v[140:143], v[32:35], 0
    v_mfma_f32_16x16x32_bf16 v[202:205], v[132:135], v[36:39], v[202:205]
    v_add_f32_dpp v17, v199, v198 row_ror:8 row_mask:0xf bank_mask:0x3
    s_waitcnt vmcnt(12)
    buffer_load_dwordx4 v[128:131], v2, s[12:15], s34 offen offset:2048 nt
    v_mfma_f32_16x16x32_bf16 v[222:225], v[144:147], v[32:35], 0
    v_mfma_f32_16x16x32_bf16 v[208:211], v[136:139], v[36:39], v[208:211]
    s_waitcnt vmcnt(12)
    buffer_load_dwordx4 v[132:135], v2, s[12:15], s34 offen offset:3072 nt
    v_mfma_f32_16x16x32_bf16 v[228:231], v[148:151], v[32:35], 0
    v_mfma_f32_16x16x32_bf16 v[214:217], v[140:143], v[36:39], v[214:217]
    v_add_f32_dpp v17, v204, v205 row_ror:8 row_mask:0xf bank_mask:0xc
    s_waitcnt vmcnt(11)
    buffer_load_dwordx4 v[136:139], v2, s[12:15], s35 offen nt
    v_mfma_f32_16x16x32_bf16 v[186:189], v[152:155], v[32:35], 0
    v_mfma_f32_16x16x32_bf16 v[220:223], v[144:147], v[36:39], v[220:223]
    v_add_f32_dpp v18, v211, v210 row_ror:8 row_mask:0xf bank_mask:0x3
    s_waitcnt vmcnt(12)
    buffer_load_dwordx4 v[140:143], v2, s[12:15], s35 offen offset:1024 nt
    v_mfma_f32_16x16x32_bf16 v[192:195], v[156:159], v[32:35], 0
    v_mfma_f32_16x16x32_bf16 v[226:229], v[148:151], v[36:39], v[226:229]
    v_add_f32_dpp v18, v216, v217 row_ror:8 row_mask:0xf bank_mask:0xc
    s_waitcnt vmcnt(12)
    buffer_load_dwordx4 v[144:147], v2, s[12:15], s35 offen offset:2048 nt
    v_mfma_f32_16x16x32_bf16 v[198:201], v[160:163], v[32:35], 0
    v_mfma_f32_16x16x32_bf16 v[184:187], v[152:155], v[36:39], v[184:187]
    v_add_f32_dpp v19, v223, v222 row_ror:8 row_mask:0xf bank_mask:0x3
    s_waitcnt vmcnt(12)
    buffer_load_dwordx4 v[148:151], v2, s[12:15], s35 offen offset:3072 nt
    s_add_u32 s34, s34, 16384
    s_add_u32 s35, s35, 16384
    v_mfma_f32_16x16x32_bf16 v[204:207], v[164:167], v[32:35], 0
    v_mfma_f32_16x16x32_bf16 v[190:193], v[156:159], v[36:39], v[190:193]
    v_add_f32_dpp v19, v228, v229 row_ror:8 row_mask:0xf bank_mask:0xc
    ds_write_b128 v14, v[16:19]
    v_max3_f32 v5, v16, v17, v5
    v_max3_f32 v5, v18, v19, v5
    v_add_u32 v14, 1024, v14
    s_waitcnt vmcnt(9)
    buffer_load_dwordx4 v[152:155], v2, s[12:15], s34 offen nt
    v_mfma_f32_16x16x32_bf16 v[210:213], v[168:171], v[32:35], 0
    v_mfma_f32_16x16x32_bf16 v[196:199], v[160:163], v[36:39], v[196:199]
    v_add_f32_dpp v16, v187, v186 row_ror:8 row_mask:0xf bank_mask:0x3
    s_waitcnt vmcnt(10)
    buffer_load_dwordx4 v[156:159], v2, s[12:15], s34 offen offset:1024 nt
    s_sub_u32 s44, s60, 1
    v_cmp_le_u32 s[64:65], s60, v4
    v_cmp_lt_u32 s[66:67], s60, v4
    v_cmp_le_u32 s[68:69], s44, v4
    s_bcnt1_i32_b64 s62, s[64:65]
    s_bcnt1_i32_b64 s44, s[66:67]
    s_add_u32 s62, s62, s61
    s_add_u32 s62, s62, s44
    s_bcnt1_i32_b64 s44, s[68:69]
    s_add_u32 s62, s62, s44
    v_mfma_f32_16x16x32_bf16 v[216:219], v[172:175], v[32:35], 0
    v_mfma_f32_16x16x32_bf16 v[202:205], v[164:167], v[36:39], v[202:205]
    v_add_f32_dpp v16, v192, v193 row_ror:8 row_mask:0xf bank_mask:0xc
    v_mfma_f32_16x16x32_bf16 v[222:225], v[176:179], v[32:35], 0
    s_sub_u32 s30, s30, 1
    s_cmp_lg_u32 s30, 0
    s_cbranch_scc1 L_head_26
    s_branch L_exit_26
L_t_26_6_7:
    s_waitcnt vmcnt(10)
    buffer_load_dwordx4 v[160:163], v2, s[12:15], s34 offen offset:2048 nt
    v_mfma_f32_16x16x32_bf16 v[208:211], v[168:171], v[36:39], v[208:211]
    v_add_f32_dpp v17, v199, v198 row_ror:8 row_mask:0xf bank_mask:0x3
    v_mfma_f32_16x16x32_bf16 v[228:231], v[180:183], v[32:35], 0
    s_waitcnt vmcnt(10)
    buffer_load_dwordx4 v[164:167], v2, s[12:15], s34 offen offset:3072 nt
    v_mfma_f32_16x16x32_bf16 v[214:217], v[172:175], v[36:39], v[214:217]
    v_add_f32_dpp v17, v204, v205 row_ror:8 row_mask:0xf bank_mask:0xc
    v_mfma_f32_16x16x32_bf16 v[186:189], v[120:123], v[32:35], 0
    v_mfma_f32_16x16x32_bf16 v[220:223], v[176:179], v[36:39], v[220:223]
    s_waitcnt vmcnt(10)
    buffer_load_dwordx4 v[168:171], v2, s[12:15], s35 offen nt
    v_add_f32_dpp v18, v211, v210 row_ror:8 row_mask:0xf bank_mask:0x3
    v_mfma_f32_16x16x32_bf16 v[192:195], v[124:127], v[32:35], 0
    v_mfma_f32_16x16x32_bf16 v[226:229], v[180:183], v[36:39], v[226:229]
    s_waitcnt vmcnt(10)
    buffer_load_dwordx4 v[172:175], v2, s[12:15], s35 offen offset:1024 nt
    s_add_u32 s60, s60, 1
    v_mov_b32 v11, s60
    s_mov_b64 exec, 1
    buffer_store_byte v11, off, s[56:59], s63
    s_mov_b64 exec, -1
    buffer_load_ubyte v4, v10, s[56:59], 0 offen nt
    v_add_f32_dpp v18, v216, v217 row_ror:8 row_mask:0xf bank_mask:0xc
    v_mfma_f32_16x16x32_bf16 v[198:201], v[128:131], v[32:35], 0
    v_mfma_f32_16x16x32_bf16 v[184:187], v[120:123], v[36:39], v[184:187]
    v_add_f32_dpp v19, v223, v222 row_ror:8 row_mask:0xf bank_mask:0x3
    s_waitcnt vmcnt(12)
    buffer_load_dwordx4 v[176:179], v2, s[12:15], s35 offen offset:2048 nt
    v_mfma_f32_16x16x32_bf16 v[190:193], v[124:127], v[36:39], v[190:193]
    v_add_f32_dpp v19, v228, v229 row_ror:8 row_mask:0xf bank_mask:0xc
    ds_write_b128 v14, v[16:19]
    v_max3_f32 v5, v16, v17, v5
    v_max3_f32 v5, v18, v19, v5
    v_add_u32 v14, 1024, v14
    s_waitcnt vmcnt(12)
    buffer_load_dwordx4 v[180:183], v2, s[12:15], s35 offen offset:3072 nt
    s_add_u32 s34, s34, 16384
    s_add_u32 s35, s35, 16384
    v_mfma_f32_16x16x32_bf16 v[204:207], v[132:135], v[32:35], 0
    v_mfma_f32_16x16x32_bf16 v[196:199], v[128:131], v[36:39], v[196:199]
    v_add_f32_dpp v16, v187, v186 row_ror:8 row_mask:0xf bank_mask:0x3
    s_waitcnt vmcnt(12)
    buffer_load_dwordx4 v[120:123], v2, s[12:15], s34 offen nt
    v_mfma_f32_16x16x32_bf16 v[210:213], v[136:139], v[32:35], 0
    v_add_f32_dpp v16, v192, v193 row_ror:8 row_mask:0xf bank_mask:0xc
    s_waitcnt vmcnt(12)
    buffer_load_dwordx4 v[124:127], v2, s[12:15], s34 offen offset:1024 nt
    v_mfma_f32_16x16x32_bf16 v[216:219], v[140:143], v[32:35], 0
    v_mfma_f32_16x16x32_bf16 v[202:205], v[132:135], v[36:39], v[202:205]
    v_add_f32_dpp v17, v199, v198 row_ror:8 row_mask:0xf bank_mask:0x3
    s_waitcnt vmcnt(12)
    buffer_load_dwordx4 v[128:131], v2, s[12:15], s34 offen offset:2048 nt
    v_mfma_f32_16x16x32_bf16 v[222:225], v[144:147], v[32:35], 0
    v_mfma_f32_16x16x32_bf16 v[208:211], v[136:139], v[36:39], v[208:211]
    s_waitcnt vmcnt(12)
    buffer_load_dwordx4 v[132:135], v2, s[12:15], s34 offen offset:3072 nt
    v_mfma_f32_16x16x32_bf16 v[228:231], v[148:151], v[32:35], 0
    v_mfma_f32_16x16x32_bf16 v[214:217], v[140:143], v[36:39], v[214:217]
    v_add_f32_dpp v17, v204, v205 row_ror:8 row_mask:0xf bank_mask:0xc
    s_waitcnt vmcnt(12)
    buffer_load_dwordx4 v[136:139], v2, s[12:15], s35 offen nt
    v_mfma_f32_16x16x32_bf16 v[186:189], v[152:155], v[32:35], 0
    v_mfma_f32_16x16x32_bf16 v[220:223], v[144:147], v[36:39], v[220:223]
    v_add_f32_dpp v18, v211, v210 row_ror:8 row_mask:0xf bank_mask:0x3
    s_waitcnt vmcnt(12)
    buffer_load_dwordx4 v[140:143], v2, s[12:15], s35 offen offset:1024 nt
    v_mfma_f32_16x16x32_bf16 v[192:195], v[156:159], v[32:35], 0
    v_mfma_f32_16x16x32_bf16 v[226:229], v[148:151], v[36:39], v[226:229]
    v_add_f32_dpp v18, v216, v217 row_ror:8 row_mask:0xf bank_mask:0xc
    s_waitcnt vmcnt(12)
    buffer_load_dwordx4 v[144:147], v2, s[12:15], s35 offen offset:2048 nt
    v_mfma_f32_16x16x32_bf16 v[198:201], v[160:163], v[32:35], 0
    v_mfma_f32_16x16x32_bf16 v[184:187], v[152:155], v[36:39], v[184:187]
    v_add_f32_dpp v19, v223, v222 row_ror:8 row_mask:0xf bank_mask:0x3
    s_waitcnt vmcnt(12)
    buffer_load_dwordx4 v[148:151], v2, s[12:15], s35 offen offset:3072 nt
    s_add_u32 s34, s34, 16384
    s_add_u32 s35, s35, 16384
    v_mfma_f32_16x16x32_bf16 v[204:207], v[164:167], v[32:35], 0
    v_mfma_f32_16x16x32_bf16 v[190:193], v[156:159], v[36:39], v[190:193]
    v_add_f32_dpp v19, v228, v229 row_ror:8 row_mask:0xf bank_mask:0xc
    ds_write_b128 v14, v[16:19]
    v_max3_f32 v5, v16, v17, v5
    v_max3_f32 v5, v18, v19, v5
    v_add_u32 v14, 1024, v14
    s_waitcnt vmcnt(12)
    buffer_load_dwordx4 v[152:155], v2, s[12:15], s34 offen nt
    v_mfma_f32_16x16x32_bf16 v[210:213], v[168:171], v[32:35], 0
    v_mfma_f32_16x16x32_bf16 v[196:199], v[160:163], v[36:39], v[196:199]
    v_add_f32_dpp v16, v187, v186 row_ror:8 row_mask:0xf bank_mask:0x3
    s_waitcnt vmcnt(10)
    buffer_load_dwordx4 v[156:159], v2, s[12:15], s34 offen offset:1024 nt
    s_sub_u32 s44, s60, 1
    v_cmp_le_u32 s[64:65], s60, v4
    v_cmp_lt_u32 s[66:67], s60, v4
    v_cmp_le_u32 s[68:69], s44, v4
    s_bcnt1_i32_b64 s62, s[64:65]
    s_bcnt1_i32_b64 s44, s[66:67]
    s_add_u32 s62, s62, s61
    s_add_u32 s62, s62, s44
    s_bcnt1_i32_b64 s44, s[68:69]
    s_add_u32 s62, s62, s44
    v_mfma_f32_16x16x32_bf16 v[216:219], v[172:175], v[32:35], 0
    v_mfma_f32_16x16x32_bf16 v[202:205], v[164:167], v[36:39], v[202:205]
    v_add_f32_dpp v16, v192, v193 row_ror:8 row_mask:0xf bank_mask:0xc
    v_mfma_f32_16x16x32_bf16 v[222:225], v[176:179], v[32:35], 0
    s_sub_u32 s30, s30, 1
    s_cmp_lg_u32 s30, 0
    s_cbranch_scc1 L_head_26
L_exit_26:
    s_waitcnt vmcnt(9)
    buffer_load_dwordx4 v[160:163], v2, s[12:15], s34 offen offset:2048 nt
    v_mfma_f32_16x16x32_bf16 v[208:211], v[168:171], v[36:39], v[208:211]
    v_add_f32_dpp v17, v199, v198 row_ror:8 row_mask:0xf bank_mask:0x3
    v_mfma_f32_16x16x32_bf16 v[228:231], v[180:183], v[32:35], 0
    s_waitcnt vmcnt(9)
    buffer_load_dwordx4 v[164:167], v2, s[12:15], s34 offen offset:3072 nt
    v_mfma_f32_16x16x32_bf16 v[214:217], v[172:175], v[36:39], v[214:217]
    v_add_f32_dpp v17, v204, v205 row_ror:8 row_mask:0xf bank_mask:0xc
    v_mfma_f32_16x16x32_bf16 v[186:189], v[120:123], v[32:35], 0
    v_mfma_f32_16x16x32_bf16 v[220:223], v[176:179], v[36:39], v[220:223]
    s_waitcnt vmcnt(9)
    buffer_load_dwordx4 v[168:171], v2, s[12:15], s35 offen nt
    v_add_f32_dpp v18, v211, v210 row_ror:8 row_mask:0xf bank_mask:0x3
    v_mfma_f32_16x16x32_bf16 v[192:195], v[124:127], v[32:35], 0
    v_mfma_f32_16x16x32_bf16 v[226:229], v[180:183], v[36:39], v[226:229]
    s_waitcnt vmcnt(9)
    buffer_load_dwordx4 v[172:175], v2, s[12:15], s35 offen offset:1024 nt
    s_add_u32 s60, s60, 1
    v_mov_b32 v11, s60
    s_mov_b64 exec, 1
    buffer_store_byte v11, off, s[56:59], s63
    s_mov_b64 exec, -1
    buffer_load_ubyte v4, v10, s[56:59], 0 offen nt
    v_add_f32_dpp v18, v216, v217 row_ror:8 row_mask:0xf bank_mask:0xc
    v_mfma_f32_16x16x32_bf16 v[198:201], v[128:131], v[32:35], 0
    v_mfma_f32_16x16x32_bf16 v[184:187], v[120:123], v[36:39], v[184:187]
    v_add_f32_dpp v19, v223, v222 row_ror:8 row_mask:0xf bank_mask:0x3
    s_waitcnt vmcnt(11)
    buffer_load_dwordx4 v[176:179], v2, s[12:15], s35 offen offset:2048 nt
    v_mfma_f32_16x16x32_bf16 v[190:193], v[124:127], v[36:39], v[190:193]
    v_add_f32_dpp v19, v228, v229 row_ror:8 row_mask:0xf bank_mask:0xc
    ds_write_b128 v14, v[16:19]
    v_max3_f32 v5, v16, v17, v5
    v_max3_f32 v5, v18, v19, v5
    v_add_u32 v14, 1024, v14
    s_waitcnt vmcnt(11)
    buffer_load_dwordx4 v[180:183], v2, s[12:15], s35 offen offset:3072 nt
    s_mov_b32 s34, s38
    s_add_u32 s35, s38, 4096
    v_mfma_f32_16x16x32_bf16 v[204:207], v[132:135], v[32:35], 0
    v_mfma_f32_16x16x32_bf16 v[196:199], v[128:131], v[36:39], v[196:199]
    v_add_f32_dpp v16, v187, v186 row_ror:8 row_mask:0xf bank_mask:0x3
    s_waitcnt vmcnt(11)
    buffer_load_dwordx4 v[120:123], v3, s[16:19], s34 offen nt
    v_mfma_f32_16x16x32_bf16 v[210:213], v[136:139], v[32:35], 0
    v_add_f32_dpp v16, v192, v193 row_ror:8 row_mask:0xf bank_mask:0xc
    s_waitcnt vmcnt(11)
    buffer_load_dwordx4 v[124:127], v3, s[16:19], s34 offen offset:1024 nt
    v_mfma_f32_16x16x32_bf16 v[216:219], v[140:143], v[32:35], 0
    v_mfma_f32_16x16x32_bf16 v[202:205], v[132:135], v[36:39], v[202:205]
    v_add_f32_dpp v17, v199, v198 row_ror:8 row_mask:0xf bank_mask:0x3
    s_waitcnt vmcnt(11)
    buffer_load_dwordx4 v[128:131], v3, s[16:19], s34 offen offset:2048 nt
    v_mfma_f32_16x16x32_bf16 v[222:225], v[144:147], v[32:35], 0
    v_mfma_f32_16x16x32_bf16 v[208:211], v[136:139], v[36:39], v[208:211]
    s_waitcnt vmcnt(11)
    buffer_load_dwordx4 v[132:135], v3, s[16:19], s34 offen offset:3072 nt
    v_mfma_f32_16x16x32_bf16 v[228:231], v[148:151], v[32:35], 0
    v_mfma_f32_16x16x32_bf16 v[214:217], v[140:143], v[36:39], v[214:217]
    v_add_f32_dpp v17, v204, v205 row_ror:8 row_mask:0xf bank_mask:0xc
    s_waitcnt vmcnt(11)
    buffer_load_dwordx4 v[136:139], v3, s[16:19], s35 offen nt
    v_mfma_f32_16x16x32_bf16 v[186:189], v[152:155], v[32:35], 0
    v_mfma_f32_16x16x32_bf16 v[220:223], v[144:147], v[36:39], v[220:223]
    v_add_f32_dpp v18, v211, v210 row_ror:8 row_mask:0xf bank_mask:0x3
    s_waitcnt vmcnt(11)
    buffer_load_dwordx4 v[140:143], v3, s[16:19], s35 offen offset:1024 nt
    v_mfma_f32_16x16x32_bf16 v[192:195], v[156:159], v[32:35], 0
    v_mfma_f32_16x16x32_bf16 v[226:229], v[148:151], v[36:39], v[226:229]
    v_add_f32_dpp v18, v216, v217 row_ror:8 row_mask:0xf bank_mask:0xc
    s_waitcnt vmcnt(11)
    buffer_load_dwordx4 v[144:147], v3, s[16:19], s35 offen offset:2048 nt
    v_mfma_f32_16x16x32_bf16 v[198:201], v[160:163], v[32:35], 0
    v_mfma_f32_16x16x32_bf16 v[184:187], v[152:155], v[36:39], v[184:187]
    v_add_f32_dpp v19, v223, v222 row_ror:8 row_mask:0xf bank_mask:0x3
    s_waitcnt vmcnt(11)
    buffer_load_dwordx4 v[148:151], v3, s[16:19], s35 offen offset:3072 nt
    s_add_u32 s34, s34, 16384
    s_add_u32 s35, s35, 16384
    v_mfma_f32_16x16x32_bf16 v[204:207], v[164:167], v[32:35], 0
    v_mfma_f32_16x16x32_bf16 v[190:193], v[156:159], v[36:39], v[190:193]
    v_add_f32_dpp v19, v228, v229 row_ror:8 row_mask:0xf bank_mask:0xc
    ds_write_b128 v14, v[16:19]
    v_max3_f32 v5, v16, v17, v5
    v_max3_f32 v5, v18, v19, v5
    v_add_u32 v14, 1024, v14
    s_waitcnt vmcnt(9)
    buffer_load_dwordx4 v[152:155], v3, s[16:19], s34 offen nt
    v_mfma_f32_16x16x32_bf16 v[210:213], v[168:171], v[32:35], 0
    v_mfma_f32_16x16x32_bf16 v[196:199], v[160:163], v[36:39], v[196:199]
    v_add_f32_dpp v16, v187, v186 row_ror:8 row_mask:0xf bank_mask:0x3
    s_waitcnt vmcnt(9)
    buffer_load_dwordx4 v[156:159], v3, s[16:19], s34 offen offset:1024 nt
    s_sub_u32 s44, s60, 1
    v_cmp_le_u32 s[64:65], s60, v4
    v_cmp_lt_u32 s[66:67], s60, v4
    v_cmp_le_u32 s[68:69], s44, v4
    s_bcnt1_i32_b64 s62, s[64:65]
    s_bcnt1_i32_b64 s44, s[66:67]
    s_add_u32 s62, s62, s61
    s_add_u32 s62, s62, s44
    s_bcnt1_i32_b64 s44, s[68:69]
    s_add_u32 s62, s62, s44
    v_mfma_f32_16x16x32_bf16 v[216:219], v[172:175], v[32:35], 0
    v_mfma_f32_16x16x32_bf16 v[202:205], v[164:167], v[36:39], v[202:205]
    v_add_f32_dpp v16, v192, v193 row_ror:8 row_mask:0xf bank_mask:0xc
    v_mfma_f32_16x16x32_bf16 v[222:225], v[176:179], v[32:35], 0
    s_waitcnt vmcnt(9)
    buffer_load_dwordx4 v[160:163], v3, s[16:19], s34 offen offset:2048 nt
    v_mfma_f32_16x16x32_bf16 v[208:211], v[168:171], v[36:39], v[208:211]
    v_add_f32_dpp v17, v199, v198 row_ror:8 row_mask:0xf bank_mask:0x3
    v_mfma_f32_16x16x32_bf16 v[228:231], v[180:183], v[32:35], 0
    s_waitcnt vmcnt(9)
    buffer_load_dwordx4 v[164:167], v3, s[16:19], s34 offen offset:3072 nt
    v_mfma_f32_16x16x32_bf16 v[214:217], v[172:175], v[36:39], v[214:217]
    v_add_f32_dpp v17, v204, v205 row_ror:8 row_mask:0xf bank_mask:0xc
    v_mfma_f32_16x16x32_bf16 v[220:223], v[176:179], v[36:39], v[220:223]
    s_waitcnt vmcnt(9)
    buffer_load_dwordx4 v[168:171], v3, s[16:19], s35 offen nt
    v_add_f32_dpp v18, v211, v210 row_ror:8 row_mask:0xf bank_mask:0x3
    v_mfma_f32_16x16x32_bf16 v[226:229], v[180:183], v[36:39], v[226:229]
    s_waitcnt vmcnt(9)
    buffer_load_dwordx4 v[172:175], v3, s[16:19], s35 offen offset:1024 nt
    s_add_u32 s60, s60, 1
    v_mov_b32 v11, s60
    s_mov_b64 exec, 1
    buffer_store_byte v11, off, s[56:59], s63
    s_mov_b64 exec, -1
    buffer_load_ubyte v4, v10, s[56:59], 0 offen nt
    v_perm_b32 v88, v128, v120, s32
    v_perm_b32 v92, v128, v120, s33
    v_perm_b32 v96, v129, v121, s32
    v_perm_b32 v100, v129, v121, s33
    v_perm_b32 v104, v130, v122, s32
    v_perm_b32 v108, v130, v122, s33
    v_perm_b32 v112, v131, v123, s32
    v_perm_b32 v116, v131, v123, s33
    v_add_f32_dpp v18, v216, v217 row_ror:8 row_mask:0xf bank_mask:0xc
    s_waitcnt vmcnt(11)
    buffer_load_dwordx4 v[176:179], v3, s[16:19], s35 offen offset:2048 nt
    v_add_f32_dpp v19, v223, v222 row_ror:8 row_mask:0xf bank_mask:0x3
    s_nop 1
    v_add_f32_dpp v19, v228, v229 row_ror:8 row_mask:0xf bank_mask:0xc
    ds_write_b128 v14, v[16:19]
    v_max3_f32 v5, v16, v17, v5
    v_max3_f32 v5, v18, v19, v5
    v_add_u32 v14, 1024, v14
    ds_read_b128 v[20:23], v15
    v_add_u32 v15, 1024, v15
    s_waitcnt vmcnt(11)
    buffer_load_dwordx4 v[180:183], v3, s[16:19], s35 offen offset:3072 nt
    s_add_u32 s34, s34, 16384
    s_add_u32 s35, s35, 16384
    v_mov_b32 v8, v5
    v_mov_b32 v9, v8
    s_nop 1
    v_permlane16_swap_b32 v8, v9
    v_max_f32 v8, v8, v9
    v_mov_b32 v9, v8
    s_nop 1
    v_permlane32_swap_b32 v8, v9
    v_max_f32 v8, v8, v9
    s_nop 1
    v_max_f32_dpp v5, v8, v8 row_ror:8 row_mask:0xf bank_mask:0xf
    v_mul_f32 v6, s31, v5
    s_waitcnt vmcnt(11)
    buffer_load_dwordx4 v[120:123], v3, s[16:19], s34 offen nt
    s_waitcnt lgkmcnt(0)
    v_fma_f32 v16, v20, s31, -v6
    v_fma_f32 v17, v21, s31, -v6
    v_fma_f32 v18, v22, s31, -v6
    v_fma_f32 v19, v23, s31, -v6
    ds_read_b128 v[20:23], v15
    v_add_u32 v15, 1024, v15
    v_exp_f32 v16, v16
    v_exp_f32 v17, v17
    v_exp_f32 v18, v18
    v_exp_f32 v19, v19
    s_waitcnt vmcnt(11)
    v_cvt_pk_bf16_f32 v28, v16, v17
    v_cvt_pk_bf16_f32 v29, v18, v19
    v_add_f32 v8, v16, v17
    v_add_f32 v9, v18, v19
    v_and_b32 v24, v28, v12
    v_and_b32 v25, v29, v12
    v_and_b32 v26, v28, v13
    v_and_b32 v27, v29, v13
    v_add_f32 v8, v8, v9
    v_add_f32 v7, v7, v8
    v_perm_b32 v90, v132, v124, s32
    v_perm_b32 v94, v132, v124, s33
    v_perm_b32 v98, v133, v125, s32
    v_perm_b32 v102, v133, v125, s33
    v_perm_b32 v106, v134, v126, s32
    v_perm_b32 v110, v134, v126, s33
    v_perm_b32 v114, v135, v127, s32
    v_perm_b32 v118, v135, v127, s33
    buffer_load_dwordx4 v[124:127], v3, s[16:19], s34 offen offset:1024 nt
    s_waitcnt lgkmcnt(0)
    v_fma_f32 v16, v20, s31, -v6
    v_fma_f32 v17, v21, s31, -v6
    v_fma_f32 v18, v22, s31, -v6
    v_fma_f32 v19, v23, s31, -v6
    ds_read_b128 v[20:23], v15
    v_add_u32 v15, 1024, v15
    v_exp_f32 v16, v16
    v_exp_f32 v17, v17
    v_exp_f32 v18, v18
    v_exp_f32 v19, v19
    s_waitcnt vmcnt(11)
    buffer_load_dwordx4 v[128:131], v3, s[16:19], s34 offen offset:2048 nt
    v_perm_b32 v89, v144, v136, s32
    v_perm_b32 v93, v144, v136, s33
    v_perm_b32 v97, v145, v137, s32
    v_perm_b32 v101, v145, v137, s33
    v_perm_b32 v105, v146, v138, s32
    v_perm_b32 v109, v146, v138, s33
    v_perm_b32 v113, v147, v139, s32
    v_perm_b32 v117, v147, v139, s33
    s_waitcnt vmcnt(11)
    buffer_load_dwordx4 v[132:135], v3, s[16:19], s34 offen offset:3072 nt
    v_perm_b32 v91, v148, v140, s32
    v_perm_b32 v95, v148, v140, s33
    v_perm_b32 v99, v149, v141, s32
    v_perm_b32 v103, v149, v141, s33
    v_perm_b32 v107, v150, v142, s32
    v_perm_b32 v111, v150, v142, s33
    v_perm_b32 v115, v151, v143, s32
    v_perm_b32 v119, v151, v143, s33
    v_mfma_f32_16x16x32_bf16 v[56:59], v[88:91], v[24:27], v[56:59]
    v_mfma_f32_16x16x32_bf16 v[60:63], v[92:95], v[24:27], v[60:63]
    v_mfma_f32_16x16x32_bf16 v[64:67], v[96:99], v[24:27], v[64:67]
    v_mfma_f32_16x16x32_bf16 v[68:71], v[100:103], v[24:27], v[68:71]
    s_waitcnt vmcnt(11)
    buffer_load_dwordx4 v[136:139], v3, s[16:19], s35 offen nt
    v_mfma_f32_16x16x32_bf16 v[72:75], v[104:107], v[24:27], v[72:75]
    v_mfma_f32_16x16x32_bf16 v[76:79], v[108:111], v[24:27], v[76:79]
    v_mfma_f32_16x16x32_bf16 v[80:83], v[112:115], v[24:27], v[80:83]
    v_mfma_f32_16x16x32_bf16 v[84:87], v[116:119], v[24:27], v[84:87]
    s_waitcnt vmcnt(11)
    buffer_load_dwordx4 v[140:143], v3, s[16:19], s35 offen offset:1024 nt
    v_cvt_pk_bf16_f32 v28, v16, v17
    v_cvt_pk_bf16_f32 v29, v18, v19
    v_add_f32 v8, v16, v17
    v_add_f32 v9, v18, v19
    v_and_b32 v24, v28, v12
    v_and_b32 v25, v29, v12
    v_and_b32 v26, v28, v13
    v_and_b32 v27, v29, v13
    v_add_f32 v8, v8, v9
    v_add_f32 v7, v7, v8
    s_waitcnt vmcnt(11)
    buffer_load_dwordx4 v[144:147], v3, s[16:19], s35 offen offset:2048 nt
    v_perm_b32 v88, v160, v152, s32
    v_perm_b32 v92, v160, v152, s33
    v_perm_b32 v96, v161, v153, s32
    v_perm_b32 v100, v161, v153, s33
    v_perm_b32 v104, v162, v154, s32
    v_perm_b32 v108, v162, v154, s33
    v_perm_b32 v112, v163, v155, s32
    v_perm_b32 v116, v163, v155, s33
    s_waitcnt vmcnt(11)
    buffer_load_dwordx4 v[148:151], v3, s[16:19], s35 offen offset:3072 nt
    s_add_u32 s34, s34, 16384
    s_add_u32 s35, s35, 16384
    v_perm_b32 v90, v164, v156, s32
    v_perm_b32 v94, v164, v156, s33
    v_perm_b32 v98, v165, v157, s32
    v_perm_b32 v102, v165, v157, s33
    v_perm_b32 v106, v166, v158, s32
    v_perm_b32 v110, v166, v158, s33
    v_perm_b32 v114, v167, v159, s32
    v_perm_b32 v118, v167, v159, s33
    s_waitcnt vmcnt(9)
    buffer_load_dwordx4 v[152:155], v3, s[16:19], s34 offen nt
    s_waitcnt lgkmcnt(0)
    v_fma_f32 v16, v20, s31, -v6
    v_fma_f32 v17, v21, s31, -v6
    v_fma_f32 v18, v22, s31, -v6
    v_fma_f32 v19, v23, s31, -v6
    ds_read_b128 v[20:23], v15
    v_add_u32 v15, 1024, v15
    v_exp_f32 v16, v16
    v_exp_f32 v17, v17
    v_exp_f32 v18, v18
    v_exp_f32 v19, v19
    s_waitcnt vmcnt(9)
    buffer_load_dwordx4 v[156:159], v3, s[16:19], s34 offen offset:1024 nt
    s_sub_u32 s44, s60, 1
    v_cmp_le_u32 s[64:65], s60, v4
    v_cmp_lt_u32 s[66:67], s60, v4
    v_cmp_le_u32 s[68:69], s44, v4
    s_bcnt1_i32_b64 s62, s[64:65]
    s_bcnt1_i32_b64 s44, s[66:67]
    s_add_u32 s62, s62, s61
    s_add_u32 s62, s62, s44
    s_bcnt1_i32_b64 s44, s[68:69]
    s_add_u32 s62, s62, s44
    s_mov_b32 s30, 30
L_head_538:
    s_cmp_ge_u32 s62, 102
    s_cbranch_scc1 L_t_538_3_7
    s_cmp_ge_u32 s62, 78
    s_cbranch_scc1 L_t_538_1_3
    s_waitcnt vmcnt(8)
    buffer_load_dwordx4 v[160:163], v3, s[16:19], s34 offen offset:2048 nt
    v_perm_b32 v89, v176, v168, s32
    v_perm_b32 v93, v176, v168, s33
    v_perm_b32 v97, v177, v169, s32
    v_perm_b32 v101, v177, v169, s33
    v_perm_b32 v105, v178, v170, s32
    v_perm_b32 v109, v178, v170, s33
    v_perm_b32 v113, v179, v171, s32
    v_perm_b32 v117, v179, v171, s33
    s_waitcnt vmcnt(9)
    buffer_load_dwordx4 v[164:167], v3, s[16:19], s34 offen offset:3072 nt
    v_perm_b32 v91, v180, v172, s32
    v_perm_b32 v95, v180, v172, s33
    v_perm_b32 v99, v181, v173, s32
    v_perm_b32 v103, v181, v173, s33
    v_perm_b32 v107, v182, v174, s32
    v_perm_b32 v111, v182, v174, s33
    v_perm_b32 v115, v183, v175, s32
    v_perm_b32 v119, v183, v175, s33
    v_mfma_f32_16x16x32_bf16 v[56:59], v[88:91], v[24:27], v[56:59]
    v_mfma_f32_16x16x32_bf16 v[60:63], v[92:95], v[24:27], v[60:63]
    v_mfma_f32_16x16x32_bf16 v[64:67], v[96:99], v[24:27], v[64:67]
    v_mfma_f32_16x16x32_bf16 v[68:71], v[100:103], v[24:27], v[68:71]
    s_waitcnt vmcnt(8)
    buffer_load_dwordx4 v[168:171], v3, s[16:19], s35 offen nt
    v_mfma_f32_16x16x32_bf16 v[72:75], v[104:107], v[24:27], v[72:75]
    v_mfma_f32_16x16x32_bf16 v[76:79], v[108:111], v[24:27], v[76:79]
    v_mfma_f32_16x16x32_bf16 v[80:83], v[112:115], v[24:27], v[80:83]
    v_mfma_f32_16x16x32_bf16 v[84:87], v[116:119], v[24:27], v[84:87]
    s_waitcnt vmcnt(9)
    buffer_load_dwordx4 v[172:175], v3, s[16:19], s35 offen offset:1024 nt
    s_add_u32 s60, s60, 1
    v_mov_b32 v11, s60
    s_mov_b64 exec, 1
    buffer_store_byte v11, off, s[56:59], s63
    s_mov_b64 exec, -1
    buffer_load_ubyte v4, v10, s[56:59], 0 offen nt
    v_perm_b32 v88, v128, v120, s32
    v_perm_b32 v92, v128, v120, s33
    v_perm_b32 v96, v129, v121, s32
    v_perm_b32 v100, v129, v121, s33
    v_perm_b32 v104, v130, v122, s32
    v_perm_b32 v108, v130, v122, s33
    v_perm_b32 v112, v131, v123, s32
    v_perm_b32 v116, v131, v123, s33
    s_waitcnt vmcnt(10)
    buffer_load_dwordx4 v[176:179], v3, s[16:19], s35 offen offset:2048 nt
    v_cvt_pk_bf16_f32 v28, v16, v17
    v_cvt_pk_bf16_f32 v29, v18, v19
    v_add_f32 v8, v16, v17
    v_add_f32 v9, v18, v19
    v_and_b32 v24, v28, v12
    v_and_b32 v25, v29, v12
    v_and_b32 v26, v28, v13
    v_and_b32 v27, v29, v13
    v_add_f32 v8, v8, v9
    v_add_f32 v7, v7, v8
    s_waitcnt vmcnt(11)
    buffer_load_dwordx4 v[180:183], v3, s[16:19], s35 offen offset:3072 nt
    s_add_u32 s34, s34, 16384
    s_add_u32 s35, s35, 16384
    v_perm_b32 v90, v132, v124, s32
    v_perm_b32 v94, v132, v124, s33
    v_perm_b32 v98, v133, v125, s32
    v_perm_b32 v102, v133, v125, s33
    v_perm_b32 v106, v134, v126, s32
    v_perm_b32 v110, v134, v126, s33
    v_perm_b32 v114, v135, v127, s32
    v_perm_b32 v118, v135, v127, s33
    s_waitcnt vmcnt(10)
    buffer_load_dwordx4 v[120:123], v3, s[16:19], s34 offen nt
    s_waitcnt lgkmcnt(0)
    v_fma_f32 v16, v20, s31, -v6
    v_fma_f32 v17, v21, s31, -v6
    v_fma_f32 v18, v22, s31, -v6
    v_fma_f32 v19, v23, s31, -v6
    ds_read_b128 v[20:23], v15
    v_add_u32 v15, 1024, v15
    v_exp_f32 v16, v16
    v_exp_f32 v17, v17
    v_exp_f32 v18, v18
    v_exp_f32 v19, v19
    s_waitcnt vmcnt(11)
    buffer_load_dwordx4 v[124:127], v3, s[16:19], s34 offen offset:1024 nt
    s_waitcnt vmcnt(10)
    buffer_load_dwordx4 v[128:131], v3, s[16:19], s34 offen offset:2048 nt
    v_perm_b32 v89, v144, v136, s32
    v_perm_b32 v93, v144, v136, s33
    v_perm_b32 v97, v145, v137, s32
    v_perm_b32 v101, v145, v137, s33
    v_perm_b32 v105, v146, v138, s32
    v_perm_b32 v109, v146, v138, s33
    v_perm_b32 v113, v147, v139, s32
    v_perm_b32 v117, v147, v139, s33
    s_waitcnt vmcnt(11)
    buffer_load_dwordx4 v[132:135], v3, s[16:19], s34 offen offset:3072 nt
    v_perm_b32 v91, v148, v140, s32
    v_perm_b32 v95, v148, v140, s33
    v_perm_b32 v99, v149, v141, s32
    v_perm_b32 v103, v149, v141, s33
    v_perm_b32 v107, v150, v142, s32
    v_perm_b32 v111, v150, v142, s33
    v_perm_b32 v115, v151, v143, s32
    v_perm_b32 v119, v151, v143, s33
    v_mfma_f32_16x16x32_bf16 v[56:59], v[88:91], v[24:27], v[56:59]
    v_mfma_f32_16x16x32_bf16 v[60:63], v[92:95], v[24:27], v[60:63]
    v_mfma_f32_16x16x32_bf16 v[64:67], v[96:99], v[24:27], v[64:67]
    v_mfma_f32_16x16x32_bf16 v[68:71], v[100:103], v[24:27], v[68:71]
    s_waitcnt vmcnt(10)
    buffer_load_dwordx4 v[136:139], v3, s[16:19], s35 offen nt
    v_mfma_f32_16x16x32_bf16 v[72:75], v[104:107], v[24:27], v[72:75]
    v_mfma_f32_16x16x32_bf16 v[76:79], v[108:111], v[24:27], v[76:79]
    v_mfma_f32_16x16x32_bf16 v[80:83], v[112:115], v[24:27], v[80:83]
    v_mfma_f32_16x16x32_bf16 v[84:87], v[116:119], v[24:27], v[84:87]
    s_waitcnt vmcnt(11)
    buffer_load_dwordx4 v[140:143], v3, s[16:19], s35 offen offset:1024 nt
    v_cvt_pk_bf16_f32 v28, v16, v17
    v_cvt_pk_bf16_f32 v29, v18, v19
    v_add_f32 v8, v16, v17
    v_add_f32 v9, v18, v19
    v_and_b32 v24, v28, v12
    v_and_b32 v25, v29, v12
    v_and_b32 v26, v28, v13
    v_and_b32 v27, v29, v13
    v_add_f32 v8, v8, v9
    v_add_f32 v7, v7, v8
    s_waitcnt vmcnt(10)
    buffer_load_dwordx4 v[144:147], v3, s[16:19], s35 offen offset:2048 nt
    v_perm_b32 v88, v160, v152, s32
    v_perm_b32 v92, v160, v152, s33
    v_perm_b32 v96, v161, v153, s32
    v_perm_b32 v100, v161, v153, s33
    v_perm_b32 v104, v162, v154, s32
    v_perm_b32 v108, v162, v154, s33
    v_perm_b32 v112, v163, v155, s32
    v_perm_b32 v116, v163, v155, s33
    s_waitcnt vmcnt(11)
    buffer_load_dwordx4 v[148:151], v3, s[16:19], s35 offen offset:3072 nt
    s_add_u32 s34, s34, 16384
    s_add_u32 s35, s35, 16384
    v_perm_b32 v90, v164, v156, s32
    v_perm_b32 v94, v164, v156, s33
    v_perm_b32 v98, v165, v157, s32
    v_perm_b32 v102, v165, v157, s33
    v_perm_b32 v106, v166, v158, s32
    v_perm_b32 v110, v166, v158, s33
    v_perm_b32 v114, v167, v159, s32
    v_perm_b32 v118, v167, v159, s33
    s_waitcnt vmcnt(8)
    buffer_load_dwordx4 v[152:155], v3, s[16:19], s34 offen nt
    s_waitcnt lgkmcnt(0)
    v_fma_f32 v16, v20, s31, -v6
    v_fma_f32 v17, v21, s31, -v6
    v_fma_f32 v18, v22, s31, -v6
    v_fma_f32 v19, v23, s31, -v6
    ds_read_b128 v[20:23], v15
    v_add_u32 v15, 1024, v15
    v_exp_f32 v16, v16
    v_exp_f32 v17, v17
    v_exp_f32 v18, v18
    v_exp_f32 v19, v19
    s_waitcnt vmcnt(9)
    buffer_load_dwordx4 v[156:159], v3, s[16:19], s34 offen offset:1024 nt
    s_sub_u32 s44, s60, 1
    v_cmp_le_u32 s[64:65], s60, v4
    v_cmp_lt_u32 s[66:67], s60, v4
    v_cmp_le_u32 s[68:69], s44, v4
    s_bcnt1_i32_b64 s62, s[64:65]
    s_bcnt1_i32_b64 s44, s[66:67]
    s_add_u32 s62, s62, s61
    s_add_u32 s62, s62, s44
    s_bcnt1_i32_b64 s44, s[68:69]
    s_add_u32 s62, s62, s44
    s_sub_u32 s30, s30, 1
    s_cmp_lg_u32 s30, 0
    s_cbranch_scc1 L_head_538
    s_branch L_exit_538
L_t_538_1_3:
    s_cmp_ge_u32 s62, 90
    s_cbranch_scc1 L_t_538_2_3
    s_waitcnt vmcnt(9)
    buffer_load_dwordx4 v[160:163], v3, s[16:19], s34 offen offset:2048 nt
    v_perm_b32 v89, v176, v168, s32
    v_perm_b32 v93, v176, v168, s33
    v_perm_b32 v97, v177, v169, s32
    v_perm_b32 v101, v177, v169, s33
    v_perm_b32 v105, v178, v170, s32
    v_perm_b32 v109, v178, v170, s33
    v_perm_b32 v113, v179, v171, s32
    v_perm_b32 v117, v179, v171, s33
    s_waitcnt vmcnt(9)
    buffer_load_dwordx4 v[164:167], v3, s[16:19], s34 offen offset:3072 nt
    v_perm_b32 v91, v180, v172, s32
    v_perm_b32 v95, v180, v172, s33
    v_perm_b32 v99, v181, v173, s32
    v_perm_b32 v103, v181, v173, s33
    v_perm_b32 v107, v182, v174, s32
    v_perm_b32 v111, v182, v174, s33
    v_perm_b32 v115, v183, v175, s32
    v_perm_b32 v119, v183, v175, s33
    v_mfma_f32_16x16x32_bf16 v[56:59], v[88:91], v[24:27], v[56:59]
    v_mfma_f32_16x16x32_bf16 v[60:63], v[92:95], v[24:27], v[60:63]
    v_mfma_f32_16x16x32_bf16 v[64:67], v[96:99], v[24:27], v[64:67]
    v_mfma_f32_16x16x32_bf16 v[68:71], v[100:103], v[24:27], v[68:71]
    s_waitcnt vmcnt(8)
    buffer_load_dwordx4 v[168:171], v3, s[16:19], s35 offen nt
    v_mfma_f32_16x16x32_bf16 v[72:75], v[104:107], v[24:27], v[72:75]
    v_mfma_f32_16x16x32_bf16 v[76:79], v[108:111], v[24:27], v[76:79]
    v_mfma_f32_16x16x32_bf16 v[80:83], v[112:115], v[24:27], v[80:83]
    v_mfma_f32_16x16x32_bf16 v[84:87], v[116:119], v[24:27], v[84:87]
    s_waitcnt vmcnt(9)
    buffer_load_dwordx4 v[172:175], v3, s[16:19], s35 offen offset:1024 nt
    s_add_u32 s60, s60, 1
    v_mov_b32 v11, s60
    s_mov_b64 exec, 1
    buffer_store_byte v11, off, s[56:59], s63
    s_mov_b64 exec, -1
    buffer_load_ubyte v4, v10, s[56:59], 0 offen nt
    v_perm_b32 v88, v128, v120, s32
    v_perm_b32 v92, v128, v120, s33
    v_perm_b32 v96, v129, v121, s32
    v_perm_b32 v100, v129, v121, s33
    v_perm_b32 v104, v130, v122, s32
    v_perm_b32 v108, v130, v122, s33
    v_perm_b32 v112, v131, v123, s32
    v_perm_b32 v116, v131, v123, s33
    s_waitcnt vmcnt(11)
    buffer_load_dwordx4 v[176:179], v3, s[16:19], s35 offen offset:2048 nt
    v_cvt_pk_bf16_f32 v28, v16, v17
    v_cvt_pk_bf16_f32 v29, v18, v19
    v_add_f32 v8, v16, v17
    v_add_f32 v9, v18, v19
    v_and_b32 v24, v28, v12
    v_and_b32 v25, v29, v12
    v_and_b32 v26, v28, v13
    v_and_b32 v27, v29, v13
    v_add_f32 v8, v8, v9
    v_add_f32 v7, v7, v8
    s_waitcnt vmcnt(11)
    buffer_load_dwordx4 v[180:183], v3, s[16:19], s35 offen offset:3072 nt
    s_add_u32 s34, s34, 16384
    s_add_u32 s35, s35, 16384
    v_perm_b32 v90, v132, v124, s32
    v_perm_b32 v94, v132, v124, s33
    v_perm_b32 v98, v133, v125, s32
    v_perm_b32 v102, v133, v125, s33
    v_perm_b32 v106, v134, v126, s32
    v_perm_b32 v110, v134, v126, s33
    v_perm_b32 v114, v135, v127, s32
    v_perm_b32 v118, v135, v127, s33
    s_waitcnt vmcnt(10)
    buffer_load_dwordx4 v[120:123], v3, s[16:19], s34 offen nt
    s_waitcnt lgkmcnt(0)
    v_fma_f32 v16, v20, s31, -v6
    v_fma_f32 v17, v21, s31, -v6
    v_fma_f32 v18, v22, s31, -v6
    v_fma_f32 v19, v23, s31, -v6
    ds_read_b128 v[20:23], v15
    v_add_u32 v15, 1024, v15
    v_exp_f32 v16, v16
    v_exp_f32 v17, v17
    v_exp_f32 v18, v18
    v_exp_f32 v19, v19
    s_waitcnt vmcnt(11)
    buffer_load_dwordx4 v[124:127], v3, s[16:19], s34 offen offset:1024 nt
    s_waitcnt vmcnt(11)
    buffer_load_dwordx4 v[128:131], v3, s[16:19], s34 offen offset:2048 nt
    v_perm_b32 v89, v144, v136, s32
    v_perm_b32 v93, v144, v136, s33
    v_perm_b32 v97, v145, v137, s32
    v_perm_b32 v101, v145, v137, s33
    v_perm_b32 v105, v146, v138, s32
    v_perm_b32 v109, v146, v138, s33
    v_perm_b32 v113, v147, v139, s32
    v_perm_b32 v117, v147, v139, s33
    s_waitcnt vmcnt(11)
    buffer_load_dwordx4 v[132:135], v3, s[16:19], s34 offen offset:3072 nt
    v_perm_b32 v91, v148, v140, s32
    v_perm_b32 v95, v148, v140, s33
    v_perm_b32 v99, v149, v141, s32
    v_perm_b32 v103, v149, v141, s33
    v_perm_b32 v107, v150, v142, s32
    v_perm_b32 v111, v150, v142, s33
    v_perm_b32 v115, v151, v143, s32
    v_perm_b32 v119, v151, v143, s33
    v_mfma_f32_16x16x32_bf16 v[56:59], v[88:91], v[24:27], v[56:59]
    v_mfma_f32_16x16x32_bf16 v[60:63], v[92:95], v[24:27], v[60:63]
    v_mfma_f32_16x16x32_bf16 v[64:67], v[96:99], v[24:27], v[64:67]
    v_mfma_f32_16x16x32_bf16 v[68:71], v[100:103], v[24:27], v[68:71]
    s_waitcnt vmcnt(10)
    buffer_load_dwordx4 v[136:139], v3, s[16:19], s35 offen nt
    v_mfma_f32_16x16x32_bf16 v[72:75], v[104:107], v[24:27], v[72:75]
    v_mfma_f32_16x16x32_bf16 v[76:79], v[108:111], v[24:27], v[76:79]
    v_mfma_f32_16x16x32_bf16 v[80:83], v[112:115], v[24:27], v[80:83]
    v_mfma_f32_16x16x32_bf16 v[84:87], v[116:119], v[24:27], v[84:87]
    s_waitcnt vmcnt(11)
    buffer_load_dwordx4 v[140:143], v3, s[16:19], s35 offen offset:1024 nt
    v_cvt_pk_bf16_f32 v28, v16, v17
    v_cvt_pk_bf16_f32 v29, v18, v19
    v_add_f32 v8, v16, v17
    v_add_f32 v9, v18, v19
    v_and_b32 v24, v28, v12
    v_and_b32 v25, v29, v12
    v_and_b32 v26, v28, v13
    v_and_b32 v27, v29, v13
    v_add_f32 v8, v8, v9
    v_add_f32 v7, v7, v8
    s_waitcnt vmcnt(11)
    buffer_load_dwordx4 v[144:147], v3, s[16:19], s35 offen offset:2048 nt
    v_perm_b32 v88, v160, v152, s32
    v_perm_b32 v92, v160, v152, s33
    v_perm_b32 v96, v161, v153, s32
    v_perm_b32 v100, v161, v153, s33
    v_perm_b32 v104, v162, v154, s32
    v_perm_b32 v108, v162, v154, s33
    v_perm_b32 v112, v163, v155, s32
    v_perm_b32 v116, v163, v155, s33
    s_waitcnt vmcnt(11)
    buffer_load_dwordx4 v[148:151], v3, s[16:19], s35 offen offset:3072 nt
    s_add_u32 s34, s34, 16384
    s_add_u32 s35, s35, 16384
    v_perm_b32 v90, v164, v156, s32
    v_perm_b32 v94, v164, v156, s33
    v_perm_b32 v98, v165, v157, s32
    v_perm_b32 v102, v165, v157, s33
    v_perm_b32 v106, v166, v158, s32
    v_perm_b32 v110, v166, v158, s33
    v_perm_b32 v114, v167, v159, s32
    v_perm_b32 v118, v167, v159, s33
    s_waitcnt vmcnt(8)
    buffer_load_dwordx4 v[152:155], v3, s[16:19], s34 offen nt
    s_waitcnt lgkmcnt(0)
    v_fma_f32 v16, v20, s31, -v6
    v_fma_f32 v17, v21, s31, -v6
    v_fma_f32 v18, v22, s31, -v6
    v_fma_f32 v19, v23, s31, -v6
    ds_read_b128 v[20:23], v15
    v_add_u32 v15, 1024, v15
    v_exp_f32 v16, v16
    v_exp_f32 v17, v17
    v_exp_f32 v18, v18
    v_exp_f32 v19, v19
    s_waitcnt vmcnt(9)
    buffer_load_dwordx4 v[156:159], v3, s[16:19], s34 offen offset:1024 nt
    s_sub_u32 s44, s60, 1
    v_cmp_le_u32 s[64:65], s60, v4
    v_cmp_lt_u32 s[66:67], s60, v4
    v_cmp_le_u32 s[68:69], s44, v4
    s_bcnt1_i32_b64 s62, s[64:65]
    s_bcnt1_i32_b64 s44, s[66:67]
    s_add_u32 s62, s62, s61
    s_add_u32 s62, s62, s44
    s_bcnt1_i32_b64 s44, s[68:69]
    s_add_u32 s62, s62, s44
    s_sub_u32 s30, s30, 1
    s_cmp_lg_u32 s30, 0
    s_cbranch_scc1 L_head_538
    s_branch L_exit_538
L_t_538_2_3:
    s_waitcnt vmcnt(9)
    buffer_load_dwordx4 v[160:163], v3, s[16:19], s34 offen offset:2048 nt
    v_perm_b32 v89, v176, v168, s32
    v_perm_b32 v93, v176, v168, s33
    v_perm_b32 v97, v177, v169, s32
    v_perm_b32 v101, v177, v169, s33
    v_perm_b32 v105, v178, v170, s32
    v_perm_b32 v109, v178, v170, s33
    v_perm_b32 v113, v179, v171, s32
    v_perm_b32 v117, v179, v171, s33
    s_waitcnt vmcnt(9)
    buffer_load_dwordx4 v[164:167], v3, s[16:19], s34 offen offset:3072 nt
    v_perm_b32 v91, v180, v172, s32
    v_perm_b32 v95, v180, v172, s33
    v_perm_b32 v99, v181, v173, s32
    v_perm_b32 v103, v181, v173, s33
    v_perm_b32 v107, v182, v174, s32
    v_perm_b32 v111, v182, v174, s33
    v_perm_b32 v115, v183, v175, s32
    v_perm_b32 v119, v183, v175, s33
    v_mfma_f32_16x16x32_bf16 v[56:59], v[88:91], v[24:27], v[56:59]
    v_mfma_f32_16x16x32_bf16 v[60:63], v[92:95], v[24:27], v[60:63]
    v_mfma_f32_16x16x32_bf16 v[64:67], v[96:99], v[24:27], v[64:67]
    v_mfma_f32_16x16x32_bf16 v[68:71], v[100:103], v[24:27], v[68:71]
    s_waitcnt vmcnt(9)
    buffer_load_dwordx4 v[168:171], v3, s[16:19], s35 offen nt
    v_mfma_f32_16x16x32_bf16 v[72:75], v[104:107], v[24:27], v[72:75]
    v_mfma_f32_16x16x32_bf16 v[76:79], v[108:111], v[24:27], v[76:79]
    v_mfma_f32_16x16x32_bf16 v[80:83], v[112:115], v[24:27], v[80:83]
    v_mfma_f32_16x16x32_bf16 v[84:87], v[116:119], v[24:27], v[84:87]
    s_waitcnt vmcnt(9)
    buffer_load_dwordx4 v[172:175], v3, s[16:19], s35 offen offset:1024 nt
    s_add_u32 s60, s60, 1
    v_mov_b32 v11, s60
    s_mov_b64 exec, 1
    buffer_store_byte v11, off, s[56:59], s63
    s_mov_b64 exec, -1
    buffer_load_ubyte v4, v10, s[56:59], 0 offen nt
    v_perm_b32 v88, v128, v120, s32
    v_perm_b32 v92, v128, v120, s33
    v_perm_b32 v96, v129, v121, s32
    v_perm_b32 v100, v129, v121, s33
    v_perm_b32 v104, v130, v122, s32
    v_perm_b32 v108, v130, v122, s33
    v_perm_b32 v112, v131, v123, s32
    v_perm_b32 v116, v131, v123, s33
    s_waitcnt vmcnt(11)
    buffer_load_dwordx4 v[176:179], v3, s[16:19], s35 offen offset:2048 nt
    v_cvt_pk_bf16_f32 v28, v16, v17
    v_cvt_pk_bf16_f32 v29, v18, v19
    v_add_f32 v8, v16, v17
    v_add_f32 v9, v18, v19
    v_and_b32 v24, v28, v12
    v_and_b32 v25, v29, v12
    v_and_b32 v26, v28, v13
    v_and_b32 v27, v29, v13
    v_add_f32 v8, v8, v9
    v_add_f32 v7, v7, v8
    s_waitcnt vmcnt(11)
    buffer_load_dwordx4 v[180:183], v3, s[16:19], s35 offen offset:3072 nt
    s_add_u32 s34, s34, 16384
    s_add_u32 s35, s35, 16384
    v_perm_b32 v90, v132, v124, s32
    v_perm_b32 v94, v132, v124, s33
    v_perm_b32 v98, v133, v125, s32
    v_perm_b32 v102, v133, v125, s33
    v_perm_b32 v106, v134, v126, s32
    v_perm_b32 v110, v134, v126, s33
    v_perm_b32 v114, v135, v127, s32
    v_perm_b32 v118, v135, v127, s33
    s_waitcnt vmcnt(11)
    buffer_load_dwordx4 v[120:123], v3, s[16:19], s34 offen nt
    s_waitcnt lgkmcnt(0)
    v_fma_f32 v16, v20, s31, -v6
    v_fma_f32 v17, v21, s31, -v6
    v_fma_f32 v18, v22, s31, -v6
    v_fma_f32 v19, v23, s31, -v6
    ds_read_b128 v[20:23], v15
    v_add_u32 v15, 1024, v15
    v_exp_f32 v16, v16
    v_exp_f32 v17, v17
    v_exp_f32 v18, v18
    v_exp_f32 v19, v19
    s_waitcnt vmcnt(11)
    buffer_load_dwordx4 v[124:127], v3, s[16:19], s34 offen offset:1024 nt
    s_waitcnt vmcnt(11)
    buffer_load_dwordx4 v[128:131], v3, s[16:19], s34 offen offset:2048 nt
    v_perm_b32 v89, v144, v136, s32
    v_perm_b32 v93, v144, v136, s33
    v_perm_b32 v97, v145, v137, s32
    v_perm_b32 v101, v145, v137, s33
    v_perm_b32 v105, v146, v138, s32
    v_perm_b32 v109, v146, v138, s33
    v_perm_b32 v113, v147, v139, s32
    v_perm_b32 v117, v147, v139, s33
    s_waitcnt vmcnt(11)
    buffer_load_dwordx4 v[132:135], v3, s[16:19], s34 offen offset:3072 nt
    v_perm_b32 v91, v148, v140, s32
    v_perm_b32 v95, v148, v140, s33
    v_perm_b32 v99, v149, v141, s32
    v_perm_b32 v103, v149, v141, s33
    v_perm_b32 v107, v150, v142, s32
    v_perm_b32 v111, v150, v142, s33
    v_perm_b32 v115, v151, v143, s32
    v_perm_b32 v119, v151, v143, s33
    v_mfma_f32_16x16x32_bf16 v[56:59], v[88:91], v[24:27], v[56:59]
    v_mfma_f32_16x16x32_bf16 v[60:63], v[92:95], v[24:27], v[60:63]
    v_mfma_f32_16x16x32_bf16 v[64:67], v[96:99], v[24:27], v[64:67]
    v_mfma_f32_16x16x32_bf16 v[68:71], v[100:103], v[24:27], v[68:71]
    s_waitcnt vmcnt(11)
    buffer_load_dwordx4 v[136:139], v3, s[16:19], s35 offen nt
    v_mfma_f32_16x16x32_bf16 v[72:75], v[104:107], v[24:27], v[72:75]
    v_mfma_f32_16x16x32_bf16 v[76:79], v[108:111], v[24:27], v[76:79]
    v_mfma_f32_16x16x32_bf16 v[80:83], v[112:115], v[24:27], v[80:83]
    v_mfma_f32_16x16x32_bf16 v[84:87], v[116:119], v[24:27], v[84:87]
    s_waitcnt vmcnt(11)
    buffer_load_dwordx4 v[140:143], v3, s[16:19], s35 offen offset:1024 nt
    v_cvt_pk_bf16_f32 v28, v16, v17
    v_cvt_pk_bf16_f32 v29, v18, v19
    v_add_f32 v8, v16, v17
    v_add_f32 v9, v18, v19
    v_and_b32 v24, v28, v12
    v_and_b32 v25, v29, v12
    v_and_b32 v26, v28, v13
    v_and_b32 v27, v29, v13
    v_add_f32 v8, v8, v9
    v_add_f32 v7, v7, v8
    s_waitcnt vmcnt(11)
    buffer_load_dwordx4 v[144:147], v3, s[16:19], s35 offen offset:2048 nt
    v_perm_b32 v88, v160, v152, s32
    v_perm_b32 v92, v160, v152, s33
    v_perm_b32 v96, v161, v153, s32
    v_perm_b32 v100, v161, v153, s33
    v_perm_b32 v104, v162, v154, s32
    v_perm_b32 v108, v162, v154, s33
    v_perm_b32 v112, v163, v155, s32
    v_perm_b32 v116, v163, v155, s33
    s_waitcnt vmcnt(11)
    buffer_load_dwordx4 v[148:151], v3, s[16:19], s35 offen offset:3072 nt
    s_add_u32 s34, s34, 16384
    s_add_u32 s35, s35, 16384
    v_perm_b32 v90, v164, v156, s32
    v_perm_b32 v94, v164, v156, s33
    v_perm_b32 v98, v165, v157, s32
    v_perm_b32 v102, v165, v157, s33
    v_perm_b32 v106, v166, v158, s32
    v_perm_b32 v110, v166, v158, s33
    v_perm_b32 v114, v167, v159, s32
    v_perm_b32 v118, v167, v159, s33
    s_waitcnt vmcnt(9)
    buffer_load_dwordx4 v[152:155], v3, s[16:19], s34 offen nt
    s_waitcnt lgkmcnt(0)
    v_fma_f32 v16, v20, s31, -v6
    v_fma_f32 v17, v21, s31, -v6
    v_fma_f32 v18, v22, s31, -v6
    v_fma_f32 v19, v23, s31, -v6
    ds_read_b128 v[20:23], v15
    v_add_u32 v15, 1024, v15
    v_exp_f32 v16, v16
    v_exp_f32 v17, v17
    v_exp_f32 v18, v18
    v_exp_f32 v19, v19
    s_waitcnt vmcnt(9)
    buffer_load_dwordx4 v[156:159], v3, s[16:19], s34 offen offset:1024 nt
    s_sub_u32 s44, s60, 1
    v_cmp_le_u32 s[64:65], s60, v4
    v_cmp_lt_u32 s[66:67], s60, v4
    v_cmp_le_u32 s[68:69], s44, v4
    s_bcnt1_i32_b64 s62, s[64:65]
    s_bcnt1_i32_b64 s44, s[66:67]
    s_add_u32 s62, s62, s61
    s_add_u32 s62, s62, s44
    s_bcnt1_i32_b64 s44, s[68:69]
    s_add_u32 s62, s62, s44
    s_sub_u32 s30, s30, 1
    s_cmp_lg_u32 s30, 0
    s_cbranch_scc1 L_head_538
    s_branch L_exit_538
L_t_538_3_7:
    s_cmp_ge_u32 s62, 126
    s_cbranch_scc1 L_t_538_5_7
    s_cmp_ge_u32 s62, 114
    s_cbranch_scc1 L_t_538_4_5
    s_waitcnt vmcnt(9)
    buffer_load_dwordx4 v[160:163], v3, s[16:19], s34 offen offset:2048 nt
    v_perm_b32 v89, v176, v168, s32
    v_perm_b32 v93, v176, v168, s33
    v_perm_b32 v97, v177, v169, s32
    v_perm_b32 v101, v177, v169, s33
    v_perm_b32 v105, v178, v170, s32
    v_perm_b32 v109, v178, v170, s33
    v_perm_b32 v113, v179, v171, s32
    v_perm_b32 v117, v179, v171, s33
    s_waitcnt vmcnt(10)
    buffer_load_dwordx4 v[164:167], v3, s[16:19], s34 offen offset:3072 nt
    v_perm_b32 v91, v180, v172, s32
    v_perm_b32 v95, v180, v172, s33
    v_perm_b32 v99, v181, v173, s32
    v_perm_b32 v103, v181, v173, s33
    v_perm_b32 v107, v182, v174, s32
    v_perm_b32 v111, v182, v174, s33
    v_perm_b32 v115, v183, v175, s32
    v_perm_b32 v119, v183, v175, s33
    v_mfma_f32_16x16x32_bf16 v[56:59], v[88:91], v[24:27], v[56:59]
    v_mfma_f32_16x16x32_bf16 v[60:63], v[92:95], v[24:27], v[60:63]
    v_mfma_f32_16x16x32_bf16 v[64:67], v[96:99], v[24:27], v[64:67]
    v_mfma_f32_16x16x32_bf16 v[68:71], v[100:103], v[24:27], v[68:71]
    s_waitcnt vmcnt(9)
    buffer_load_dwordx4 v[168:171], v3, s[16:19], s35 offen nt
    v_mfma_f32_16x16x32_bf16 v[72:75], v[104:107], v[24:27], v[72:75]
    v_mfma_f32_16x16x32_bf16 v[76:79], v[108:111], v[24:27], v[76:79]
    v_mfma_f32_16x16x32_bf16 v[80:83], v[112:115], v[24:27], v[80:83]
    v_mfma_f32_16x16x32_bf16 v[84:87], v[116:119], v[24:27], v[84:87]
    s_waitcnt vmcnt(9)
    buffer_load_dwordx4 v[172:175], v3, s[16:19], s35 offen offset:1024 nt
    s_add_u32 s60, s60, 1
    v_mov_b32 v11, s60
    s_mov_b64 exec, 1
    buffer_store_byte v11, off, s[56:59], s63
    s_mov_b64 exec, -1
    buffer_load_ubyte v4, v10, s[56:59], 0 offen nt
    v_perm_b32 v88, v128, v120, s32
    v_perm_b32 v92, v128, v120, s33
    v_perm_b32 v96, v129, v121, s32
    v_perm_b32 v100, v129, v121, s33
    v_perm_b32 v104, v130, v122, s32
    v_perm_b32 v108, v130, v122, s33
    v_perm_b32 v112, v131, v123, s32
    v_perm_b32 v116, v131, v123, s33
    s_waitcnt vmcnt(11)
    buffer_load_dwordx4 v[176:179], v3, s[16:19], s35 offen offset:2048 nt
    v_cvt_pk_bf16_f32 v28, v16, v17
    v_cvt_pk_bf16_f32 v29, v18, v19
    v_add_f32 v8, v16, v17
    v_add_f32 v9, v18, v19
    v_and_b32 v24, v28, v12
    v_and_b32 v25, v29, v12
    v_and_b32 v26, v28, v13
    v_and_b32 v27, v29, v13
    v_add_f32 v8, v8, v9
    v_add_f32 v7, v7, v8
    s_waitcnt vmcnt(12)
    buffer_load_dwordx4 v[180:183], v3, s[16:19], s35 offen offset:3072 nt
    s_add_u32 s34, s34, 16384
    s_add_u32 s35, s35, 16384
    v_perm_b32 v90, v132, v124, s32
    v_perm_b32 v94, v132, v124, s33
    v_perm_b32 v98, v133, v125, s32
    v_perm_b32 v102, v133, v125, s33
    v_perm_b32 v106, v134, v126, s32
    v_perm_b32 v110, v134, v126, s33
    v_perm_b32 v114, v135, v127, s32
    v_perm_b32 v118, v135, v127, s33
    s_waitcnt vmcnt(11)
    buffer_load_dwordx4 v[120:123], v3, s[16:19], s34 offen nt
    s_waitcnt lgkmcnt(0)
    v_fma_f32 v16, v20, s31, -v6
    v_fma_f32 v17, v21, s31, -v6
    v_fma_f32 v18, v22, s31, -v6
    v_fma_f32 v19, v23, s31, -v6
    ds_read_b128 v[20:23], v15
    v_add_u32 v15, 1024, v15
    v_exp_f32 v16, v16
    v_exp_f32 v17, v17
    v_exp_f32 v18, v18
    v_exp_f32 v19, v19
    s_waitcnt vmcnt(11)
    buffer_load_dwordx4 v[124:127], v3, s[16:19], s34 offen offset:1024 nt
    s_waitcnt vmcnt(11)
    buffer_load_dwordx4 v[128:131], v3, s[16:19], s34 offen offset:2048 nt
    v_perm_b32 v89, v144, v136, s32
    v_perm_b32 v93, v144, v136, s33
    v_perm_b32 v97, v145, v137, s32
    v_perm_b32 v101, v145, v137, s33
    v_perm_b32 v105, v146, v138, s32
    v_perm_b32 v109, v146, v138, s33
    v_perm_b32 v113, v147, v139, s32
    v_perm_b32 v117, v147, v139, s33
    s_waitcnt vmcnt(12)
    buffer_load_dwordx4 v[132:135], v3, s[16:19], s34 offen offset:3072 nt
    v_perm_b32 v91, v148, v140, s32
    v_perm_b32 v95, v148, v140, s33
    v_perm_b32 v99, v149, v141, s32
    v_perm_b32 v103, v149, v141, s33
    v_perm_b32 v107, v150, v142, s32
    v_perm_b32 v111, v150, v142, s33
    v_perm_b32 v115, v151, v143, s32
    v_perm_b32 v119, v151, v143, s33
    v_mfma_f32_16x16x32_bf16 v[56:59], v[88:91], v[24:27], v[56:59]
    v_mfma_f32_16x16x32_bf16 v[60:63], v[92:95], v[24:27], v[60:63]
    v_mfma_f32_16x16x32_bf16 v[64:67], v[96:99], v[24:27], v[64:67]
    v_mfma_f32_16x16x32_bf16 v[68:71], v[100:103], v[24:27], v[68:71]
    s_waitcnt vmcnt(11)
    buffer_load_dwordx4 v[136:139], v3, s[16:19], s35 offen nt
    v_mfma_f32_16x16x32_bf16 v[72:75], v[104:107], v[24:27], v[72:75]
    v_mfma_f32_16x16x32_bf16 v[76:79], v[108:111], v[24:27], v[76:79]
    v_mfma_f32_16x16x32_bf16 v[80:83], v[112:115], v[24:27], v[80:83]
    v_mfma_f32_16x16x32_bf16 v[84:87], v[116:119], v[24:27], v[84:87]
    s_waitcnt vmcnt(11)
    buffer_load_dwordx4 v[140:143], v3, s[16:19], s35 offen offset:1024 nt
    v_cvt_pk_bf16_f32 v28, v16, v17
    v_cvt_pk_bf16_f32 v29, v18, v19
    v_add_f32 v8, v16, v17
    v_add_f32 v9, v18, v19
    v_and_b32 v24, v28, v12
    v_and_b32 v25, v29, v12
    v_and_b32 v26, v28, v13
    v_and_b32 v27, v29, v13
    v_add_f32 v8, v8, v9
    v_add_f32 v7, v7, v8
    s_waitcnt vmcnt(11)
    buffer_load_dwordx4 v[144:147], v3, s[16:19], s35 offen offset:2048 nt
    v_perm_b32 v88, v160, v152, s32
    v_perm_b32 v92, v160, v152, s33
    v_perm_b32 v96, v161, v153, s32
    v_perm_b32 v100, v161, v153, s33
    v_perm_b32 v104, v162, v154, s32
    v_perm_b32 v108, v162, v154, s33
    v_perm_b32 v112, v163, v155, s32
    v_perm_b32 v116, v163, v155, s33
    s_waitcnt vmcnt(12)
    buffer_load_dwordx4 v[148:151], v3, s[16:19], s35 offen offset:3072 nt
    s_add_u32 s34, s34, 16384
    s_add_u32 s35, s35, 16384
    v_perm_b32 v90, v164, v156, s32
    v_perm_b32 v94, v164, v156, s33
    v_perm_b32 v98, v165, v157, s32
    v_perm_b32 v102, v165, v157, s33
    v_perm_b32 v106, v166, v158, s32
    v_perm_b32 v110, v166, v158, s33
    v_perm_b32 v114, v167, v159, s32
    v_perm_b32 v118, v167, v159, s33
    s_waitcnt vmcnt(9)
    buffer_load_dwordx4 v[152:155], v3, s[16:19], s34 offen nt
    s_waitcnt lgkmcnt(0)
    v_fma_f32 v16, v20, s31, -v6
    v_fma_f32 v17, v21, s31, -v6
    v_fma_f32 v18, v22, s31, -v6
    v_fma_f32 v19, v23, s31, -v6
    ds_read_b128 v[20:23], v15
    v_add_u32 v15, 1024, v15
    v_exp_f32 v16, v16
    v_exp_f32 v17, v17
    v_exp_f32 v18, v18
    v_exp_f32 v19, v19
    s_waitcnt vmcnt(9)
    buffer_load_dwordx4 v[156:159], v3, s[16:19], s34 offen offset:1024 nt
    s_sub_u32 s44, s60, 1
    v_cmp_le_u32 s[64:65], s60, v4
    v_cmp_lt_u32 s[66:67], s60, v4
    v_cmp_le_u32 s[68:69], s44, v4
    s_bcnt1_i32_b64 s62, s[64:65]
    s_bcnt1_i32_b64 s44, s[66:67]
    s_add_u32 s62, s62, s61
    s_add_u32 s62, s62, s44
    s_bcnt1_i32_b64 s44, s[68:69]
    s_add_u32 s62, s62, s44
    s_sub_u32 s30, s30, 1
    s_cmp_lg_u32 s30, 0
    s_cbranch_scc1 L_head_538
    s_branch L_exit_538
L_t_538_4_5:
    s_waitcnt vmcnt(9)
    buffer_load_dwordx4 v[160:163], v3, s[16:19], s34 offen offset:2048 nt
    v_perm_b32 v89, v176, v168, s32
    v_perm_b32 v93, v176, v168, s33
    v_perm_b32 v97, v177, v169, s32
    v_perm_b32 v101, v177, v169, s33
    v_perm_b32 v105, v178, v170, s32
    v_perm_b32 v109, v178, v170, s33
    v_perm_b32 v113, v179, v171, s32
    v_perm_b32 v117, v179, v171, s33
    s_waitcnt vmcnt(10)
    buffer_load_dwordx4 v[164:167], v3, s[16:19], s34 offen offset:3072 nt
    v_perm_b32 v91, v180, v172, s32
    v_perm_b32 v95, v180, v172, s33
    v_perm_b32 v99, v181, v173, s32
    v_perm_b32 v103, v181, v173, s33
    v_perm_b32 v107, v182, v174, s32
    v_perm_b32 v111, v182, v174, s33
    v_perm_b32 v115, v183, v175, s32
    v_perm_b32 v119, v183, v175, s33
    v_mfma_f32_16x16x32_bf16 v[56:59], v[88:91], v[24:27], v[56:59]
    v_mfma_f32_16x16x32_bf16 v[60:63], v[92:95], v[24:27], v[60:63]
    v_mfma_f32_16x16x32_bf16 v[64:67], v[96:99], v[24:27], v[64:67]
    v_mfma_f32_16x16x32_bf16 v[68:71], v[100:103], v[24:27], v[68:71]
    s_waitcnt vmcnt(9)
    buffer_load_dwordx4 v[168:171], v3, s[16:19], s35 offen nt
    v_mfma_f32_16x16x32_bf16 v[72:75], v[104:107], v[24:27], v[72:75]
    v_mfma_f32_16x16x32_bf16 v[76:79], v[108:111], v[24:27], v[76:79]
    v_mfma_f32_16x16x32_bf16 v[80:83], v[112:115], v[24:27], v[80:83]
    v_mfma_f32_16x16x32_bf16 v[84:87], v[116:119], v[24:27], v[84:87]
    s_waitcnt vmcnt(10)
    buffer_load_dwordx4 v[172:175], v3, s[16:19], s35 offen offset:1024 nt
    s_add_u32 s60, s60, 1
    v_mov_b32 v11, s60
    s_mov_b64 exec, 1
    buffer_store_byte v11, off, s[56:59], s63
    s_mov_b64 exec, -1
    buffer_load_ubyte v4, v10, s[56:59], 0 offen nt
    v_perm_b32 v88, v128, v120, s32
    v_perm_b32 v92, v128, v120, s33
    v_perm_b32 v96, v129, v121, s32
    v_perm_b32 v100, v129, v121, s33
    v_perm_b32 v104, v130, v122, s32
    v_perm_b32 v108, v130, v122, s33
    v_perm_b32 v112, v131, v123, s32
    v_perm_b32 v116, v131, v123, s33
    s_waitcnt vmcnt(11)
    buffer_load_dwordx4 v[176:179], v3, s[16:19], s35 offen offset:2048 nt
    v_cvt_pk_bf16_f32 v28, v16, v17
    v_cvt_pk_bf16_f32 v29, v18, v19
    v_add_f32 v8, v16, v17
    v_add_f32 v9, v18, v19
    v_and_b32 v24, v28, v12
    v_and_b32 v25, v29, v12
    v_and_b32 v26, v28, v13
    v_and_b32 v27, v29, v13
    v_add_f32 v8, v8, v9
    v_add_f32 v7, v7, v8
    s_waitcnt vmcnt(12)
    buffer_load_dwordx4 v[180:183], v3, s[16:19], s35 offen offset:3072 nt
    s_add_u32 s34, s34, 16384
    s_add_u32 s35, s35, 16384
    v_perm_b32 v90, v132, v124, s32
    v_perm_b32 v94, v132, v124, s33
    v_perm_b32 v98, v133, v125, s32
    v_perm_b32 v102, v133, v125, s33
    v_perm_b32 v106, v134, v126, s32
    v_perm_b32 v110, v134, v126, s33
    v_perm_b32 v114, v135, v127, s32
    v_perm_b32 v118, v135, v127, s33
    s_waitcnt vmcnt(11)
    buffer_load_dwordx4 v[120:123], v3, s[16:19], s34 offen nt
    s_waitcnt lgkmcnt(0)
    v_fma_f32 v16, v20, s31, -v6
    v_fma_f32 v17, v21, s31, -v6
    v_fma_f32 v18, v22, s31, -v6
    v_fma_f32 v19, v23, s31, -v6
    ds_read_b128 v[20:23], v15
    v_add_u32 v15, 1024, v15
    v_exp_f32 v16, v16
    v_exp_f32 v17, v17
    v_exp_f32 v18, v18
    v_exp_f32 v19, v19
    s_waitcnt vmcnt(12)
    buffer_load_dwordx4 v[124:127], v3, s[16:19], s34 offen offset:1024 nt
    s_waitcnt vmcnt(11)
    buffer_load_dwordx4 v[128:131], v3, s[16:19], s34 offen offset:2048 nt
    v_perm_b32 v89, v144, v136, s32
    v_perm_b32 v93, v144, v136, s33
    v_perm_b32 v97, v145, v137, s32
    v_perm_b32 v101, v145, v137, s33
    v_perm_b32 v105, v146, v138, s32
    v_perm_b32 v109, v146, v138, s33
    v_perm_b32 v113, v147, v139, s32
    v_perm_b32 v117, v147, v139, s33
    s_waitcnt vmcnt(12)
    buffer_load_dwordx4 v[132:135], v3, s[16:19], s34 offen offset:3072 nt
    v_perm_b32 v91, v148, v140, s32
    v_perm_b32 v95, v148, v140, s33
    v_perm_b32 v99, v149, v141, s32
    v_perm_b32 v103, v149, v141, s33
    v_perm_b32 v107, v150, v142, s32
    v_perm_b32 v111, v150, v142, s33
    v_perm_b32 v115, v151, v143, s32
    v_perm_b32 v119, v151, v143, s33
    v_mfma_f32_16x16x32_bf16 v[56:59], v[88:91], v[24:27], v[56:59]
    v_mfma_f32_16x16x32_bf16 v[60:63], v[92:95], v[24:27], v[60:63]
    v_mfma_f32_16x16x32_bf16 v[64:67], v[96:99], v[24:27], v[64:67]
    v_mfma_f32_16x16x32_bf16 v[68:71], v[100:103], v[24:27], v[68:71]
    s_waitcnt vmcnt(11)
    buffer_load_dwordx4 v[136:139], v3, s[16:19], s35 offen nt
    v_mfma_f32_16x16x32_bf16 v[72:75], v[104:107], v[24:27], v[72:75]
    v_mfma_f32_16x16x32_bf16 v[76:79], v[108:111], v[24:27], v[76:79]
    v_mfma_f32_16x16x32_bf16 v[80:83], v[112:115], v[24:27], v[80:83]
    v_mfma_f32_16x16x32_bf16 v[84:87], v[116:119], v[24:27], v[84:87]
    s_waitcnt vmcnt(12)
    buffer_load_dwordx4 v[140:143], v3, s[16:19], s35 offen offset:1024 nt
    v_cvt_pk_bf16_f32 v28, v16, v17
    v_cvt_pk_bf16_f32 v29, v18, v19
    v_add_f32 v8, v16, v17
    v_add_f32 v9, v18, v19
    v_and_b32 v24, v28, v12
    v_and_b32 v25, v29, v12
    v_and_b32 v26, v28, v13
    v_and_b32 v27, v29, v13
    v_add_f32 v8, v8, v9
    v_add_f32 v7, v7, v8
    s_waitcnt vmcnt(11)
    buffer_load_dwordx4 v[144:147], v3, s[16:19], s35 offen offset:2048 nt
    v_perm_b32 v88, v160, v152, s32
    v_perm_b32 v92, v160, v152, s33
    v_perm_b32 v96, v161, v153, s32
    v_perm_b32 v100, v161, v153, s33
    v_perm_b32 v104, v162, v154, s32
    v_perm_b32 v108, v162, v154, s33
    v_perm_b32 v112, v163, v155, s32
    v_perm_b32 v116, v163, v155, s33
    s_waitcnt vmcnt(12)
    buffer_load_dwordx4 v[148:151], v3, s[16:19], s35 offen offset:3072 nt
    s_add_u32 s34, s34, 16384
    s_add_u32 s35, s35, 16384
    v_perm_b32 v90, v164, v156, s32
    v_perm_b32 v94, v164, v156, s33
    v_perm_b32 v98, v165, v157, s32
    v_perm_b32 v102, v165, v157, s33
    v_perm_b32 v106, v166, v158, s32
    v_perm_b32 v110, v166, v158, s33
    v_perm_b32 v114, v167, v159, s32
    v_perm_b32 v118, v167, v159, s33
    s_waitcnt vmcnt(9)
    buffer_load_dwordx4 v[152:155], v3, s[16:19], s34 offen nt
    s_waitcnt lgkmcnt(0)
    v_fma_f32 v16, v20, s31, -v6
    v_fma_f32 v17, v21, s31, -v6
    v_fma_f32 v18, v22, s31, -v6
    v_fma_f32 v19, v23, s31, -v6
    ds_read_b128 v[20:23], v15
    v_add_u32 v15, 1024, v15
    v_exp_f32 v16, v16
    v_exp_f32 v17, v17
    v_exp_f32 v18, v18
    v_exp_f32 v19, v19
    s_waitcnt vmcnt(10)
    buffer_load_dwordx4 v[156:159], v3, s[16:19], s34 offen offset:1024 nt
    s_sub_u32 s44, s60, 1
    v_cmp_le_u32 s[64:65], s60, v4
    v_cmp_lt_u32 s[66:67], s60, v4
    v_cmp_le_u32 s[68:69], s44, v4
    s_bcnt1_i32_b64 s62, s[64:65]
    s_bcnt1_i32_b64 s44, s[66:67]
    s_add_u32 s62, s62, s61
    s_add_u32 s62, s62, s44
    s_bcnt1_i32_b64 s44, s[68:69]
    s_add_u32 s62, s62, s44
    s_sub_u32 s30, s30, 1
    s_cmp_lg_u32 s30, 0
    s_cbranch_scc1 L_head_538
    s_branch L_exit_538
L_t_538_5_7:
    s_cmp_ge_u32 s62, 138
    s_cbranch_scc1 L_t_538_6_7
    s_waitcnt vmcnt(10)
    buffer_load_dwordx4 v[160:163], v3, s[16:19], s34 offen offset:2048 nt
    v_perm_b32 v89, v176, v168, s32
    v_perm_b32 v93, v176, v168, s33
    v_perm_b32 v97, v177, v169, s32
    v_perm_b32 v101, v177, v169, s33
    v_perm_b32 v105, v178, v170, s32
    v_perm_b32 v109, v178, v170, s33
    v_perm_b32 v113, v179, v171, s32
    v_perm_b32 v117, v179, v171, s33
    s_waitcnt vmcnt(10)
    buffer_load_dwordx4 v[164:167], v3, s[16:19], s34 offen offset:3072 nt
    v_perm_b32 v91, v180, v172, s32
    v_perm_b32 v95, v180, v172, s33
    v_perm_b32 v99, v181, v173, s32
    v_perm_b32 v103, v181, v173, s33
    v_perm_b32 v107, v182, v174, s32
    v_perm_b32 v111, v182, v174, s33
    v_perm_b32 v115, v183, v175, s32
    v_perm_b32 v119, v183, v175, s33
    v_mfma_f32_16x16x32_bf16 v[56:59], v[88:91], v[24:27], v[56:59]
    v_mfma_f32_16x16x32_bf16 v[60:63], v[92:95], v[24:27], v[60:63]
    v_mfma_f32_16x16x32_bf16 v[64:67], v[96:99], v[24:27], v[64:67]
    v_mfma_f32_16x16x32_bf16 v[68:71], v[100:103], v[24:27], v[68:71]
    s_waitcnt vmcnt(9)
    buffer_load_dwordx4 v[168:171], v3, s[16:19], s35 offen nt
    v_mfma_f32_16x16x32_bf16 v[72:75], v[104:107], v[24:27], v[72:75]
    v_mfma_f32_16x16x32_bf16 v[76:79], v[108:111], v[24:27], v[76:79]
    v_mfma_f32_16x16x32_bf16 v[80:83], v[112:115], v[24:27], v[80:83]
    v_mfma_f32_16x16x32_bf16 v[84:87], v[116:119], v[24:27], v[84:87]
    s_waitcnt vmcnt(10)
    buffer_load_dwordx4 v[172:175], v3, s[16:19], s35 offen offset:1024 nt
    s_add_u32 s60, s60, 1
    v_mov_b32 v11, s60
    s_mov_b64 exec, 1
    buffer_store_byte v11, off, s[56:59], s63
    s_mov_b64 exec, -1
    buffer_load_ubyte v4, v10, s[56:59], 0 offen nt
    v_perm_b32 v88, v128, v120, s32
    v_perm_b32 v92, v128, v120, s33
    v_perm_b32 v96, v129, v121, s32
    v_perm_b32 v100, v129, v121, s33
    v_perm_b32 v104, v130, v122, s32
    v_perm_b32 v108, v130, v122, s33
    v_perm_b32 v112, v131, v123, s32
    v_perm_b32 v116, v131, v123, s33
    s_waitcnt vmcnt(12)
    buffer_load_dwordx4 v[176:179], v3, s[16:19], s35 offen offset:2048 nt
    v_cvt_pk_bf16_f32 v28, v16, v17
    v_cvt_pk_bf16_f32 v29, v18, v19
    v_add_f32 v8, v16, v17
    v_add_f32 v9, v18, v19
    v_and_b32 v24, v28, v12
    v_and_b32 v25, v29, v12
    v_and_b32 v26, v28, v13
    v_and_b32 v27, v29, v13
    v_add_f32 v8, v8, v9
    v_add_f32 v7, v7, v8
    s_waitcnt vmcnt(12)
    buffer_load_dwordx4 v[180:183], v3, s[16:19], s35 offen offset:3072 nt
    s_add_u32 s34, s34, 16384
    s_add_u32 s35, s35, 16384
    v_perm_b32 v90, v132, v124, s32
    v_perm_b32 v94, v132, v124, s33
    v_perm_b32 v98, v133, v125, s32
    v_perm_b32 v102, v133, v125, s33
    v_perm_b32 v106, v134, v126, s32
    v_perm_b32 v110, v134, v126, s33
    v_perm_b32 v114, v135, v127, s32
    v_perm_b32 v118, v135, v127, s33
    s_waitcnt vmcnt(11)
    buffer_load_dwordx4 v[120:123], v3, s[16:19], s34 offen nt
    s_waitcnt lgkmcnt(0)
    v_fma_f32 v16, v20, s31, -v6
    v_fma_f32 v17, v21, s31, -v6
    v_fma_f32 v18, v22, s31, -v6
    v_fma_f32 v19, v23, s31, -v6
    ds_read_b128 v[20:23], v15
    v_add_u32 v15, 1024, v15
    v_exp_f32 v16, v16
    v_exp_f32 v17, v17
    v_exp_f32 v18, v18
    v_exp_f32 v19, v19
    s_waitcnt vmcnt(12)
    buffer_load_dwordx4 v[124:127], v3, s[16:19], s34 offen offset:1024 nt
    s_waitcnt vmcnt(12)
    buffer_load_dwordx4 v[128:131], v3, s[16:19], s34 offen offset:2048 nt
    v_perm_b32 v89, v144, v136, s32
    v_perm_b32 v93, v144, v136, s33
    v_perm_b32 v97, v145, v137, s32
    v_perm_b32 v101, v145, v137, s33
    v_perm_b32 v105, v146, v138, s32
    v_perm_b32 v109, v146, v138, s33
    v_perm_b32 v113, v147, v139, s32
    v_perm_b32 v117, v147, v139, s33
    s_waitcnt vmcnt(12)
    buffer_load_dwordx4 v[132:135], v3, s[16:19], s34 offen offset:3072 nt
    v_perm_b32 v91, v148, v140, s32
    v_perm_b32 v95, v148, v140, s33
    v_perm_b32 v99, v149, v141, s32
    v_perm_b32 v103, v149, v141, s33
    v_perm_b32 v107, v150, v142, s32
    v_perm_b32 v111, v150, v142, s33
    v_perm_b32 v115, v151, v143, s32
    v_perm_b32 v119, v151, v143, s33
    v_mfma_f32_16x16x32_bf16 v[56:59], v[88:91], v[24:27], v[56:59]
    v_mfma_f32_16x16x32_bf16 v[60:63], v[92:95], v[24:27], v[60:63]
    v_mfma_f32_16x16x32_bf16 v[64:67], v[96:99], v[24:27], v[64:67]
    v_mfma_f32_16x16x32_bf16 v[68:71], v[100:103], v[24:27], v[68:71]
    s_waitcnt vmcnt(11)
    buffer_load_dwordx4 v[136:139], v3, s[16:19], s35 offen nt
    v_mfma_f32_16x16x32_bf16 v[72:75], v[104:107], v[24:27], v[72:75]
    v_mfma_f32_16x16x32_bf16 v[76:79], v[108:111], v[24:27], v[76:79]
    v_mfma_f32_16x16x32_bf16 v[80:83], v[112:115], v[24:27], v[80:83]
    v_mfma_f32_16x16x32_bf16 v[84:87], v[116:119], v[24:27], v[84:87]
    s_waitcnt vmcnt(12)
    buffer_load_dwordx4 v[140:143], v3, s[16:19], s35 offen offset:1024 nt
    v_cvt_pk_bf16_f32 v28, v16, v17
    v_cvt_pk_bf16_f32 v29, v18, v19
    v_add_f32 v8, v16, v17
    v_add_f32 v9, v18, v19
    v_and_b32 v24, v28, v12
    v_and_b32 v25, v29, v12
    v_and_b32 v26, v28, v13
    v_and_b32 v27, v29, v13
    v_add_f32 v8, v8, v9
    v_add_f32 v7, v7, v8
    s_waitcnt vmcnt(12)
    buffer_load_dwordx4 v[144:147], v3, s[16:19], s35 offen offset:2048 nt
    v_perm_b32 v88, v160, v152, s32
    v_perm_b32 v92, v160, v152, s33
    v_perm_b32 v96, v161, v153, s32
    v_perm_b32 v100, v161, v153, s33
    v_perm_b32 v104, v162, v154, s32
    v_perm_b32 v108, v162, v154, s33
    v_perm_b32 v112, v163, v155, s32
    v_perm_b32 v116, v163, v155, s33
    s_waitcnt vmcnt(12)
    buffer_load_dwordx4 v[148:151], v3, s[16:19], s35 offen offset:3072 nt
    s_add_u32 s34, s34, 16384
    s_add_u32 s35, s35, 16384
    v_perm_b32 v90, v164, v156, s32
    v_perm_b32 v94, v164, v156, s33
    v_perm_b32 v98, v165, v157, s32
    v_perm_b32 v102, v165, v157, s33
    v_perm_b32 v106, v166, v158, s32
    v_perm_b32 v110, v166, v158, s33
    v_perm_b32 v114, v167, v159, s32
    v_perm_b32 v118, v167, v159, s33
    s_waitcnt vmcnt(9)
    buffer_load_dwordx4 v[152:155], v3, s[16:19], s34 offen nt
    s_waitcnt lgkmcnt(0)
    v_fma_f32 v16, v20, s31, -v6
    v_fma_f32 v17, v21, s31, -v6
    v_fma_f32 v18, v22, s31, -v6
    v_fma_f32 v19, v23, s31, -v6
    ds_read_b128 v[20:23], v15
    v_add_u32 v15, 1024, v15
    v_exp_f32 v16, v16
    v_exp_f32 v17, v17
    v_exp_f32 v18, v18
    v_exp_f32 v19, v19
    s_waitcnt vmcnt(10)
    buffer_load_dwordx4 v[156:159], v3, s[16:19], s34 offen offset:1024 nt
    s_sub_u32 s44, s60, 1
    v_cmp_le_u32 s[64:65], s60, v4
    v_cmp_lt_u32 s[66:67], s60, v4
    v_cmp_le_u32 s[68:69], s44, v4
    s_bcnt1_i32_b64 s62, s[64:65]
    s_bcnt1_i32_b64 s44, s[66:67]
    s_add_u32 s62, s62, s61
    s_add_u32 s62, s62, s44
    s_bcnt1_i32_b64 s44, s[68:69]
    s_add_u32 s62, s62, s44
    s_sub_u32 s30, s30, 1
    s_cmp_lg_u32 s30, 0
    s_cbranch_scc1 L_head_538
    s_branch L_exit_538
L_t_538_6_7:
    s_waitcnt vmcnt(10)
    buffer_load_dwordx4 v[160:163], v3, s[16:19], s34 offen offset:2048 nt
    v_perm_b32 v89, v176, v168, s32
    v_perm_b32 v93, v176, v168, s33
    v_perm_b32 v97, v177, v169, s32
    v_perm_b32 v101, v177, v169, s33
    v_perm_b32 v105, v178, v170, s32
    v_perm_b32 v109, v178, v170, s33
    v_perm_b32 v113, v179, v171, s32
    v_perm_b32 v117, v179, v171, s33
    s_waitcnt vmcnt(10)
    buffer_load_dwordx4 v[164:167], v3, s[16:19], s34 offen offset:3072 nt
    v_perm_b32 v91, v180, v172, s32
    v_perm_b32 v95, v180, v172, s33
    v_perm_b32 v99, v181, v173, s32
    v_perm_b32 v103, v181, v173, s33
    v_perm_b32 v107, v182, v174, s32
    v_perm_b32 v111, v182, v174, s33
    v_perm_b32 v115, v183, v175, s32
    v_perm_b32 v119, v183, v175, s33
    v_mfma_f32_16x16x32_bf16 v[56:59], v[88:91], v[24:27], v[56:59]
    v_mfma_f32_16x16x32_bf16 v[60:63], v[92:95], v[24:27], v[60:63]
    v_mfma_f32_16x16x32_bf16 v[64:67], v[96:99], v[24:27], v[64:67]
    v_mfma_f32_16x16x32_bf16 v[68:71], v[100:103], v[24:27], v[68:71]
    s_waitcnt vmcnt(10)
    buffer_load_dwordx4 v[168:171], v3, s[16:19], s35 offen nt
    v_mfma_f32_16x16x32_bf16 v[72:75], v[104:107], v[24:27], v[72:75]
    v_mfma_f32_16x16x32_bf16 v[76:79], v[108:111], v[24:27], v[76:79]
    v_mfma_f32_16x16x32_bf16 v[80:83], v[112:115], v[24:27], v[80:83]
    v_mfma_f32_16x16x32_bf16 v[84:87], v[116:119], v[24:27], v[84:87]
    s_waitcnt vmcnt(10)
    buffer_load_dwordx4 v[172:175], v3, s[16:19], s35 offen offset:1024 nt
    s_add_u32 s60, s60, 1
    v_mov_b32 v11, s60
    s_mov_b64 exec, 1
    buffer_store_byte v11, off, s[56:59], s63
    s_mov_b64 exec, -1
    buffer_load_ubyte v4, v10, s[56:59], 0 offen nt
    v_perm_b32 v88, v128, v120, s32
    v_perm_b32 v92, v128, v120, s33
    v_perm_b32 v96, v129, v121, s32
    v_perm_b32 v100, v129, v121, s33
    v_perm_b32 v104, v130, v122, s32
    v_perm_b32 v108, v130, v122, s33
    v_perm_b32 v112, v131, v123, s32
    v_perm_b32 v116, v131, v123, s33
    s_waitcnt vmcnt(12)
    buffer_load_dwordx4 v[176:179], v3, s[16:19], s35 offen offset:2048 nt
    v_cvt_pk_bf16_f32 v28, v16, v17
    v_cvt_pk_bf16_f32 v29, v18, v19
    v_add_f32 v8, v16, v17
    v_add_f32 v9, v18, v19
    v_and_b32 v24, v28, v12
    v_and_b32 v25, v29, v12
    v_and_b32 v26, v28, v13
    v_and_b32 v27, v29, v13
    v_add_f32 v8, v8, v9
    v_add_f32 v7, v7, v8
    s_waitcnt vmcnt(12)
    buffer_load_dwordx4 v[180:183], v3, s[16:19], s35 offen offset:3072 nt
    s_add_u32 s34, s34, 16384
    s_add_u32 s35, s35, 16384
    v_perm_b32 v90, v132, v124, s32
    v_perm_b32 v94, v132, v124, s33
    v_perm_b32 v98, v133, v125, s32
    v_perm_b32 v102, v133, v125, s33
    v_perm_b32 v106, v134, v126, s32
    v_perm_b32 v110, v134, v126, s33
    v_perm_b32 v114, v135, v127, s32
    v_perm_b32 v118, v135, v127, s33
    s_waitcnt vmcnt(12)
    buffer_load_dwordx4 v[120:123], v3, s[16:19], s34 offen nt
    s_waitcnt lgkmcnt(0)
    v_fma_f32 v16, v20, s31, -v6
    v_fma_f32 v17, v21, s31, -v6
    v_fma_f32 v18, v22, s31, -v6
    v_fma_f32 v19, v23, s31, -v6
    ds_read_b128 v[20:23], v15
    v_add_u32 v15, 1024, v15
    v_exp_f32 v16, v16
    v_exp_f32 v17, v17
    v_exp_f32 v18, v18
    v_exp_f32 v19, v19
    s_waitcnt vmcnt(12)
    buffer_load_dwordx4 v[124:127], v3, s[16:19], s34 offen offset:1024 nt
    s_waitcnt vmcnt(12)
    buffer_load_dwordx4 v[128:131], v3, s[16:19], s34 offen offset:2048 nt
    v_perm_b32 v89, v144, v136, s32
    v_perm_b32 v93, v144, v136, s33
    v_perm_b32 v97, v145, v137, s32
    v_perm_b32 v101, v145, v137, s33
    v_perm_b32 v105, v146, v138, s32
    v_perm_b32 v109, v146, v138, s33
    v_perm_b32 v113, v147, v139, s32
    v_perm_b32 v117, v147, v139, s33
    s_waitcnt vmcnt(12)
    buffer_load_dwordx4 v[132:135], v3, s[16:19], s34 offen offset:3072 nt
    v_perm_b32 v91, v148, v140, s32
    v_perm_b32 v95, v148, v140, s33
    v_perm_b32 v99, v149, v141, s32
    v_perm_b32 v103, v149, v141, s33
    v_perm_b32 v107, v150, v142, s32
    v_perm_b32 v111, v150, v142, s33
    v_perm_b32 v115, v151, v143, s32
    v_perm_b32 v119, v151, v143, s33
    v_mfma_f32_16x16x32_bf16 v[56:59], v[88:91], v[24:27], v[56:59]
    v_mfma_f32_16x16x32_bf16 v[60:63], v[92:95], v[24:27], v[60:63]
    v_mfma_f32_16x16x32_bf16 v[64:67], v[96:99], v[24:27], v[64:67]
    v_mfma_f32_16x16x32_bf16 v[68:71], v[100:103], v[24:27], v[68:71]
    s_waitcnt vmcnt(12)
    buffer_load_dwordx4 v[136:139], v3, s[16:19], s35 offen nt
    v_mfma_f32_16x16x32_bf16 v[72:75], v[104:107], v[24:27], v[72:75]
    v_mfma_f32_16x16x32_bf16 v[76:79], v[108:111], v[24:27], v[76:79]
    v_mfma_f32_16x16x32_bf16 v[80:83], v[112:115], v[24:27], v[80:83]
    v_mfma_f32_16x16x32_bf16 v[84:87], v[116:119], v[24:27], v[84:87]
    s_waitcnt vmcnt(12)
    buffer_load_dwordx4 v[140:143], v3, s[16:19], s35 offen offset:1024 nt
    v_cvt_pk_bf16_f32 v28, v16, v17
    v_cvt_pk_bf16_f32 v29, v18, v19
    v_add_f32 v8, v16, v17
    v_add_f32 v9, v18, v19
    v_and_b32 v24, v28, v12
    v_and_b32 v25, v29, v12
    v_and_b32 v26, v28, v13
    v_and_b32 v27, v29, v13
    v_add_f32 v8, v8, v9
    v_add_f32 v7, v7, v8
    s_waitcnt vmcnt(12)
    buffer_load_dwordx4 v[144:147], v3, s[16:19], s35 offen offset:2048 nt
    v_perm_b32 v88, v160, v152, s32
    v_perm_b32 v92, v160, v152, s33
    v_perm_b32 v96, v161, v153, s32
    v_perm_b32 v100, v161, v153, s33
    v_perm_b32 v104, v162, v154, s32
    v_perm_b32 v108, v162, v154, s33
    v_perm_b32 v112, v163, v155, s32
    v_perm_b32 v116, v163, v155, s33
    s_waitcnt vmcnt(12)
    buffer_load_dwordx4 v[148:151], v3, s[16:19], s35 offen offset:3072 nt
    s_add_u32 s34, s34, 16384
    s_add_u32 s35, s35, 16384
    v_perm_b32 v90, v164, v156, s32
    v_perm_b32 v94, v164, v156, s33
    v_perm_b32 v98, v165, v157, s32
    v_perm_b32 v102, v165, v157, s33
    v_perm_b32 v106, v166, v158, s32
    v_perm_b32 v110, v166, v158, s33
    v_perm_b32 v114, v167, v159, s32
    v_perm_b32 v118, v167, v159, s33
    s_waitcnt vmcnt(12)
    buffer_load_dwordx4 v[152:155], v3, s[16:19], s34 offen nt
    s_waitcnt lgkmcnt(0)
    v_fma_f32 v16, v20, s31, -v6
    v_fma_f32 v17, v21, s31, -v6
    v_fma_f32 v18, v22, s31, -v6
    v_fma_f32 v19, v23, s31, -v6
    ds_read_b128 v[20:23], v15
    v_add_u32 v15, 1024, v15
    v_exp_f32 v16, v16
    v_exp_f32 v17, v17
    v_exp_f32 v18, v18
    v_exp_f32 v19, v19
    s_waitcnt vmcnt(10)
    buffer_load_dwordx4 v[156:159], v3, s[16:19], s34 offen offset:1024 nt
    s_sub_u32 s44, s60, 1
    v_cmp_le_u32 s[64:65], s60, v4
    v_cmp_lt_u32 s[66:67], s60, v4
    v_cmp_le_u32 s[68:69], s44, v4
    s_bcnt1_i32_b64 s62, s[64:65]
    s_bcnt1_i32_b64 s44, s[66:67]
    s_add_u32 s62, s62, s61
    s_add_u32 s62, s62, s44
    s_bcnt1_i32_b64 s44, s[68:69]
    s_add_u32 s62, s62, s44
    s_sub_u32 s30, s30, 1
    s_cmp_lg_u32 s30, 0
    s_cbranch_scc1 L_head_538
L_exit_538:
    s_waitcnt vmcnt(10)
    buffer_load_dwordx4 v[160:163], v3, s[16:19], s34 offen offset:2048 nt
    v_perm_b32 v89, v176, v168, s32
    v_perm_b32 v93, v176, v168, s33
    v_perm_b32 v97, v177, v169, s32
    v_perm_b32 v101, v177, v169, s33
    v_perm_b32 v105, v178, v170, s32
    v_perm_b32 v109, v178, v170, s33
    v_perm_b32 v113, v179, v171, s32
    v_perm_b32 v117, v179, v171, s33
    buffer_load_dwordx4 v[164:167], v3, s[16:19], s34 offen offset:3072 nt
    v_perm_b32 v91, v180, v172, s32
    v_perm_b32 v95, v180, v172, s33
    v_perm_b32 v99, v181, v173, s32
    v_perm_b32 v103, v181, v173, s33
    v_perm_b32 v107, v182, v174, s32
    v_perm_b32 v111, v182, v174, s33
    v_perm_b32 v115, v183, v175, s32
    v_perm_b32 v119, v183, v175, s33
    v_mfma_f32_16x16x32_bf16 v[56:59], v[88:91], v[24:27], v[56:59]
    v_mfma_f32_16x16x32_bf16 v[60:63], v[92:95], v[24:27], v[60:63]
    v_mfma_f32_16x16x32_bf16 v[64:67], v[96:99], v[24:27], v[64:67]
    v_mfma_f32_16x16x32_bf16 v[68:71], v[100:103], v[24:27], v[68:71]
    buffer_load_dwordx4 v[168:171], v3, s[16:19], s35 offen nt
    v_mfma_f32_16x16x32_bf16 v[72:75], v[104:107], v[24:27], v[72:75]
    v_mfma_f32_16x16x32_bf16 v[76:79], v[108:111], v[24:27], v[76:79]
    v_mfma_f32_16x16x32_bf16 v[80:83], v[112:115], v[24:27], v[80:83]
    v_mfma_f32_16x16x32_bf16 v[84:87], v[116:119], v[24:27], v[84:87]
    buffer_load_dwordx4 v[172:175], v3, s[16:19], s35 offen offset:1024 nt
    v_cvt_pk_bf16_f32 v28, v16, v17
    v_cvt_pk_bf16_f32 v29, v18, v19
    v_add_f32 v8, v16, v17
    v_add_f32 v9, v18, v19
    v_and_b32 v24, v28, v12
    v_and_b32 v25, v29, v12
    v_and_b32 v26, v28, v13
    v_and_b32 v27, v29, v13
    v_add_f32 v8, v8, v9
    v_add_f32 v7, v7, v8
    buffer_load_dwordx4 v[176:179], v3, s[16:19], s35 offen offset:2048 nt
    s_waitcnt lgkmcnt(0)
    v_fma_f32 v16, v20, s31, -v6
    v_fma_f32 v17, v21, s31, -v6
    v_fma_f32 v18, v22, s31, -v6
    v_fma_f32 v19, v23, s31, -v6
    v_exp_f32 v16, v16
    v_exp_f32 v17, v17
    v_exp_f32 v18, v18
    v_exp_f32 v19, v19
    buffer_load_dwordx4 v[180:183], v3, s[16:19], s35 offen offset:3072 nt
    s_waitcnt vmcnt(13)
    v_perm_b32 v88, v128, v120, s32
    v_perm_b32 v92, v128, v120, s33
    v_perm_b32 v96, v129, v121, s32
    v_perm_b32 v100, v129, v121, s33
    v_perm_b32 v104, v130, v122, s32
    v_perm_b32 v108, v130, v122, s33
    v_perm_b32 v112, v131, v123, s32
    v_perm_b32 v116, v131, v123, s33
    s_waitcnt vmcnt(12)
    v_perm_b32 v90, v132, v124, s32
    v_perm_b32 v94, v132, v124, s33
    v_perm_b32 v98, v133, v125, s32
    v_perm_b32 v102, v133, v125, s33
    v_perm_b32 v106, v134, v126, s32
    v_perm_b32 v110, v134, v126, s33
    v_perm_b32 v114, v135, v127, s32
    v_perm_b32 v118, v135, v127, s33
    s_waitcnt vmcnt(9)
    v_perm_b32 v89, v144, v136, s32
    v_perm_b32 v93, v144, v136, s33
    v_perm_b32 v97, v145, v137, s32
    v_perm_b32 v101, v145, v137, s33
    v_perm_b32 v105, v146, v138, s32
    v_perm_b32 v109, v146, v138, s33
    v_perm_b32 v113, v147, v139, s32
    v_perm_b32 v117, v147, v139, s33
    s_waitcnt vmcnt(8)
    v_perm_b32 v91, v148, v140, s32
    v_perm_b32 v95, v148, v140, s33
    v_perm_b32 v99, v149, v141, s32
    v_perm_b32 v103, v149, v141, s33
    v_perm_b32 v107, v150, v142, s32
    v_perm_b32 v111, v150, v142, s33
    v_perm_b32 v115, v151, v143, s32
    v_perm_b32 v119, v151, v143, s33
    v_mfma_f32_16x16x32_bf16 v[56:59], v[88:91], v[24:27], v[56:59]
    v_mfma_f32_16x16x32_bf16 v[60:63], v[92:95], v[24:27], v[60:63]
    v_mfma_f32_16x16x32_bf16 v[64:67], v[96:99], v[24:27], v[64:67]
    v_mfma_f32_16x16x32_bf16 v[68:71], v[100:103], v[24:27], v[68:71]
    v_mfma_f32_16x16x32_bf16 v[72:75], v[104:107], v[24:27], v[72:75]
    v_mfma_f32_16x16x32_bf16 v[76:79], v[108:111], v[24:27], v[76:79]
    v_mfma_f32_16x16x32_bf16 v[80:83], v[112:115], v[24:27], v[80:83]
    v_mfma_f32_16x16x32_bf16 v[84:87], v[116:119], v[24:27], v[84:87]
    v_cvt_pk_bf16_f32 v28, v16, v17
    v_cvt_pk_bf16_f32 v29, v18, v19
    v_add_f32 v8, v16, v17
    v_add_f32 v9, v18, v19
    v_and_b32 v24, v28, v12
    v_and_b32 v25, v29, v12
    v_and_b32 v26, v28, v13
    v_and_b32 v27, v29, v13
    v_add_f32 v8, v8, v9
    v_add_f32 v7, v7, v8
    v_mov_b32 v9, v7
    s_nop 1
    v_permlane16_swap_b32 v7, v9
    v_add_f32 v7, v7, v9
    v_mov_b32 v9, v7
    s_nop 1
    v_permlane32_swap_b32 v7, v9
    v_add_f32 v8, v7, v9
    s_nop 1
    v_add_f32_dpp v7, v8, v8 row_ror:8 row_mask:0xf bank_mask:0xf
    s_mov_b64 exec, 0xff
    ds_write_b64 v31, v[6:7]
    s_mov_b64 exec, -1
    v_xor_b32 v31, 64, v31
    v_xor_b32 v15, 0x10000, v30
    s_waitcnt vmcnt(5)
    v_perm_b32 v88, v160, v152, s32
    v_perm_b32 v92, v160, v152, s33
    v_perm_b32 v96, v161, v153, s32
    v_perm_b32 v100, v161, v153, s33
    v_perm_b32 v104, v162, v154, s32
    v_perm_b32 v108, v162, v154, s33
    v_perm_b32 v112, v163, v155, s32
    v_perm_b32 v116, v163, v155, s33
    s_waitcnt lgkmcnt(0)
    s_barrier
    ds_read_b64 v[40:41], v31
    s_waitcnt vmcnt(4)
    v_perm_b32 v90, v164, v156, s32
    v_perm_b32 v94, v164, v156, s33
    v_perm_b32 v98, v165, v157, s32
    v_perm_b32 v102, v165, v157, s33
    v_perm_b32 v106, v166, v158, s32
    v_perm_b32 v110, v166, v158, s33
    v_perm_b32 v114, v167, v159, s32
    v_perm_b32 v118, v167, v159, s33
    s_waitcnt lgkmcnt(0)
    v_max_f32 v5, v6, v40
    v_sub_f32 v8, v6, v5
    v_sub_f32 v9, v40, v5
    v_exp_f32 v8, v8
    v_exp_f32 v9, v9
    v_mul_f32 v7, v7, v8
    v_fmac_f32 v7, v41, v9
    v_rcp_f32 v7, v7
    s_nop 0
    v_mul_f32 v7, v7, v8
    s_waitcnt vmcnt(1)
    v_perm_b32 v89, v176, v168, s32
    v_perm_b32 v93, v176, v168, s33
    v_perm_b32 v97, v177, v169, s32
    v_perm_b32 v101, v177, v169, s33
    v_perm_b32 v105, v178, v170, s32
    v_perm_b32 v109, v178, v170, s33
    v_perm_b32 v113, v179, v171, s32
    v_perm_b32 v117, v179, v171, s33
    s_waitcnt vmcnt(0)
    v_perm_b32 v91, v180, v172, s32
    v_perm_b32 v95, v180, v172, s33
    v_perm_b32 v99, v181, v173, s32
    v_perm_b32 v103, v181, v173, s33
    v_perm_b32 v107, v182, v174, s32
    v_perm_b32 v111, v182, v174, s33
    v_perm_b32 v115, v183, v175, s32
    v_perm_b32 v119, v183, v175, s33
    v_mfma_f32_16x16x32_bf16 v[56:59], v[88:91], v[24:27], v[56:59]
    v_mfma_f32_16x16x32_bf16 v[60:63], v[92:95], v[24:27], v[60:63]
    v_mfma_f32_16x16x32_bf16 v[64:67], v[96:99], v[24:27], v[64:67]
    v_mfma_f32_16x16x32_bf16 v[68:71], v[100:103], v[24:27], v[68:71]
    v_mfma_f32_16x16x32_bf16 v[72:75], v[104:107], v[24:27], v[72:75]
    v_mfma_f32_16x16x32_bf16 v[76:79], v[108:111], v[24:27], v[76:79]
    v_mfma_f32_16x16x32_bf16 v[80:83], v[112:115], v[24:27], v[80:83]
    v_mfma_f32_16x16x32_bf16 v[84:87], v[116:119], v[24:27], v[84:87]
    s_cmp_eq_u32 s28, 0
    s_cbranch_scc1 L_epi0
    v_add_f32_dpp v40, v56, v56 row_ror:8 row_mask:0xf bank_mask:0x3
    v_add_f32_dpp v41, v60, v60 row_ror:8 row_mask:0xf bank_mask:0x3
    v_add_f32_dpp v42, v64, v64 row_ror:8 row_mask:0xf bank_mask:0x3
    v_add_f32_dpp v43, v68, v68 row_ror:8 row_mask:0xf bank_mask:0x3
    v_add_f32_dpp v40, v58, v58 row_ror:8 row_mask:0xf bank_mask:0xc
    v_add_f32_dpp v41, v62, v62 row_ror:8 row_mask:0xf bank_mask:0xc
    v_add_f32_dpp v42, v66, v66 row_ror:8 row_mask:0xf bank_mask:0xc
    v_add_f32_dpp v43, v70, v70 row_ror:8 row_mask:0xf bank_mask:0xc
    v_pk_mul_f32 v[40:41], v[40:41], v[6:7] op_sel:[0,1] op_sel_hi:[1,1]
    v_pk_mul_f32 v[42:43], v[42:43], v[6:7] op_sel:[0,1] op_sel_hi:[1,1]
    ds_write_b128 v30, v[40:43] offset:0
    v_add_f32_dpp v44, v72, v72 row_ror:8 row_mask:0xf bank_mask:0x3
    v_add_f32_dpp v45, v76, v76 row_ror:8 row_mask:0xf bank_mask:0x3
    v_add_f32_dpp v46, v80, v80 row_ror:8 row_mask:0xf bank_mask:0x3
    v_add_f32_dpp v47, v84, v84 row_ror:8 row_mask:0xf bank_mask:0x3
    v_add_f32_dpp v44, v74, v74 row_ror:8 row_mask:0xf bank_mask:0xc
    v_add_f32_dpp v45, v78, v78 row_ror:8 row_mask:0xf bank_mask:0xc
    v_add_f32_dpp v46, v82, v82 row_ror:8 row_mask:0xf bank_mask:0xc
    v_add_f32_dpp v47, v86, v86 row_ror:8 row_mask:0xf bank_mask:0xc
    v_pk_mul_f32 v[44:45], v[44:45], v[6:7] op_sel:[0,1] op_sel_hi:[1,1]
    v_pk_mul_f32 v[46:47], v[46:47], v[6:7] op_sel:[0,1] op_sel_hi:[1,1]
    ds_write_b128 v30, v[44:47] offset:1024
    v_add_f32_dpp v48, v57, v57 row_ror:8 row_mask:0xf bank_mask:0x3
    v_add_f32_dpp v49, v61, v61 row_ror:8 row_mask:0xf bank_mask:0x3
    v_add_f32_dpp v50, v65, v65 row_ror:8 row_mask:0xf bank_mask:0x3
    v_add_f32_dpp v51, v69, v69 row_ror:8 row_mask:0xf bank_mask:0x3
    v_add_f32_dpp v48, v59, v59 row_ror:8 row_mask:0xf bank_mask:0xc
    v_add_f32_dpp v49, v63, v63 row_ror:8 row_mask:0xf bank_mask:0xc
    v_add_f32_dpp v50, v67, v67 row_ror:8 row_mask:0xf bank_mask:0xc
    v_add_f32_dpp v51, v71, v71 row_ror:8 row_mask:0xf bank_mask:0xc
    v_add_f32_dpp v52, v73, v73 row_ror:8 row_mask:0xf bank_mask:0x3
    v_add_f32_dpp v53, v77, v77 row_ror:8 row_mask:0xf bank_mask:0x3
    v_add_f32_dpp v54, v81, v81 row_ror:8 row_mask:0xf bank_mask:0x3
    v_add_f32_dpp v55, v85, v85 row_ror:8 row_mask:0xf bank_mask:0x3
    v_add_f32_dpp v52, v75, v75 row_ror:8 row_mask:0xf bank_mask:0xc
    v_add_f32_dpp v53, v79, v79 row_ror:8 row_mask:0xf bank_mask:0xc
    v_add_f32_dpp v54, v83, v83 row_ror:8 row_mask:0xf bank_mask:0xc
    v_add_f32_dpp v55, v87, v87 row_ror:8 row_mask:0xf bank_mask:0xc
    s_branch L_epi1
L_epi0:
    v_add_f32_dpp v40, v57, v57 row_ror:8 row_mask:0xf bank_mask:0x3
    v_add_f32_dpp v41, v61, v61 row_ror:8 row_mask:0xf bank_mask:0x3
    v_add_f32_dpp v42, v65, v65 row_ror:8 row_mask:0xf bank_mask:0x3
    v_add_f32_dpp v43, v69, v69 row_ror:8 row_mask:0xf bank_mask:0x3
    v_add_f32_dpp v40, v59, v59 row_ror:8 row_mask:0xf bank_mask:0xc
    v_add_f32_dpp v41, v63, v63 row_ror:8 row_mask:0xf bank_mask:0xc
    v_add_f32_dpp v42, v67, v67 row_ror:8 row_mask:0xf bank_mask:0xc
    v_add_f32_dpp v43, v71, v71 row_ror:8 row_mask:0xf bank_mask:0xc
    v_pk_mul_f32 v[40:41], v[40:41], v[6:7] op_sel:[0,1] op_sel_hi:[1,1]
    v_pk_mul_f32 v[42:43], v[42:43], v[6:7] op_sel:[0,1] op_sel_hi:[1,1]
    ds_write_b128 v30, v[40:43] offset:0
    v_add_f32_dpp v44, v73, v73 row_ror:8 row_mask:0xf bank_mask:0x3
    v_add_f32_dpp v45, v77, v77 row_ror:8 row_mask:0xf bank_mask:0x3
    v_add_f32_dpp v46, v81, v81 row_ror:8 row_mask:0xf bank_mask:0x3
    v_add_f32_dpp v47, v85, v85 row_ror:8 row_mask:0xf bank_mask:0x3
    v_add_f32_dpp v44, v75, v75 row_ror:8 row_mask:0xf bank_mask:0xc
    v_add_f32_dpp v45, v79, v79 row_ror:8 row_mask:0xf bank_mask:0xc
    v_add_f32_dpp v46, v83, v83 row_ror:8 row_mask:0xf bank_mask:0xc
    v_add_f32_dpp v47, v87, v87 row_ror:8 row_mask:0xf bank_mask:0xc
    v_pk_mul_f32 v[44:45], v[44:45], v[6:7] op_sel:[0,1] op_sel_hi:[1,1]
    v_pk_mul_f32 v[46:47], v[46:47], v[6:7] op_sel:[0,1] op_sel_hi:[1,1]
    ds_write_b128 v30, v[44:47] offset:1024
    v_add_f32_dpp v48, v56, v56 row_ror:8 row_mask:0xf bank_mask:0x3
    v_add_f32_dpp v49, v60, v60 row_ror:8 row_mask:0xf bank_mask:0x3
    v_add_f32_dpp v50, v64, v64 row_ror:8 row_mask:0xf bank_mask:0x3
    v_add_f32_dpp v51, v68, v68 row_ror:8 row_mask:0xf bank_mask:0x3
    v_add_f32_dpp v48, v58, v58 row_ror:8 row_mask:0xf bank_mask:0xc
    v_add_f32_dpp v49, v62, v62 row_ror:8 row_mask:0xf bank_mask:0xc
    v_add_f32_dpp v50, v66, v66 row_ror:8 row_mask:0xf bank_mask:0xc
    v_add_f32_dpp v51, v70, v70 row_ror:8 row_mask:0xf bank_mask:0xc
    v_add_f32_dpp v52, v72, v72 row_ror:8 row_mask:0xf bank_mask:0x3
    v_add_f32_dpp v53, v76, v76 row_ror:8 row_mask:0xf bank_mask:0x3
    v_add_f32_dpp v54, v80, v80 row_ror:8 row_mask:0xf bank_mask:0x3
    v_add_f32_dpp v55, v84, v84 row_ror:8 row_mask:0xf bank_mask:0x3
    v_add_f32_dpp v52, v74, v74 row_ror:8 row_mask:0xf bank_mask:0xc
    v_add_f32_dpp v53, v78, v78 row_ror:8 row_mask:0xf bank_mask:0xc
    v_add_f32_dpp v54, v82, v82 row_ror:8 row_mask:0xf bank_mask:0xc
    v_add_f32_dpp v55, v86, v86 row_ror:8 row_mask:0xf bank_mask:0xc
L_epi1:
    s_waitcnt lgkmcnt(0)
    s_barrier
    ds_read_b128 v[16:19], v15
    ds_read_b128 v[20:23], v15 offset:1024
    s_waitcnt lgkmcnt(1)
    v_pk_fma_f32 v[16:17], v[48:49], v[6:7], v[16:17] op_sel:[0,1,0] op_sel_hi:[1,1,1]
    v_pk_fma_f32 v[18:19], v[50:51], v[6:7], v[18:19] op_sel:[0,1,0] op_sel_hi:[1,1,1]
    v_cvt_pk_bf16_f32 v24, v16, v17
    v_cvt_pk_bf16_f32 v25, v18, v19
    s_waitcnt lgkmcnt(0)
    v_pk_fma_f32 v[20:21], v[52:53], v[6:7], v[20:21] op_sel:[0,1,0] op_sel_hi:[1,1,1]
    v_pk_fma_f32 v[22:23], v[54:55], v[6:7], v[22:23] op_sel:[0,1,0] op_sel_hi:[1,1,1]
    v_cvt_pk_bf16_f32 v26, v20, v21
    v_cvt_pk_bf16_f32 v27, v22, v23
    buffer_store_dwordx4 v[24:27], v0, s[24:27], 0 offen
L_fin:
L_end:
    s_endpgm
.section .rodata,"a"
.p2align 6
.amdhsa_kernel standalone__mha_softmax__sampling_kernel
  .amdhsa_next_free_vgpr 233
  .amdhsa_next_free_sgpr 80
  .amdhsa_accum_offset 236
  .amdhsa_group_segment_fixed_size 0
  .amdhsa_kernarg_size 48
  .amdhsa_user_sgpr_count 2
  .amdhsa_user_sgpr_kernarg_segment_ptr 1
  .amdhsa_system_sgpr_workgroup_id_x 1
.end_amdhsa_kernel
```
